```python
import torch

def _softmax(x, axis=-1):
    return torch.softmax(x, dim=axis)
def _gelu(x):
    return torch.nn.functional.gelu(x, approximate="tanh")
def _silu(x):
    return torch.nn.functional.silu(x)
def _sigmoid(x):
    return torch.sigmoid(x)
def _layernorm(x, axis=-1, eps=1e-5):
    m = x.mean(dim=axis, keepdim=True)
    v = x.var(dim=axis, keepdim=True, unbiased=False)
    return (x - m) / torch.sqrt(v + eps)
def _scatter_add(tgt, idx, src, axis=0):
    return tgt.clone().index_add_(axis, idx, src)
def _segment_sum(src, seg, n):
    out = torch.zeros((n,) + src.shape[1:], dtype=src.dtype)
    return out.index_add_(0, seg, src)
def _pad(x, pw):
    flat = tuple(v for pair in reversed(pw) for v in pair)
    return torch.nn.functional.pad(x, flat)

kernel_name = 'sequential_preLN__spectral_fnet__dense_activation_relu__prompt'

def setup_inputs():

    _w = (lambda a: (lambda t: t.to(torch.bfloat16) if t.is_floating_point() else t)(torch.as_tensor(a)))
    def _A_setup():
        B, S, D = 1, 2048, 1024
        ns = torch.arange(S)[:, None] * torch.arange(S)[None, :]
        nd = torch.arange(D)[:, None] * torch.arange(D)[None, :]
        Ws_re = torch.cos(-2.0 * torch.pi * ns / S).to(float)
        Ws_im = torch.sin(-2.0 * torch.pi * ns / S).to(float)
        Wd_re = torch.cos(-2.0 * torch.pi * nd / D).to(float)
        Wd_im = torch.sin(-2.0 * torch.pi * nd / D).to(float)
        return {
            "x": _w((lambda *s: torch.randn(*s, dtype=torch.bfloat16) * 0.05)(B, S, D)),
            "dft_seq_re": _w(Ws_re),
            "dft_seq_im": _w(Ws_im),
            "dft_hid_re": _w(Wd_re),
            "dft_hid_im": _w(Wd_im),
        }
    _A_in = _A_setup()

    def _B_setup():
        B, S, D, Dff = 1, 2048, 1024, 3584
        return {
            "x": _w((lambda *s: torch.randn(*s, dtype=torch.bfloat16) * 0.05)(B, S, D)),
            "w1": _w((lambda *s: torch.randn(*s, dtype=torch.bfloat16) * 0.4)(D, Dff)),
            "w2": _w((lambda *s: torch.randn(*s, dtype=torch.bfloat16) * 0.4)(Dff, D)),
        }
    _B_in = _B_setup()

    return {
        "A_x": _A_in["x"],
        "A_dft_seq_re": _A_in["dft_seq_re"],
        "A_dft_seq_im": _A_in["dft_seq_im"],
        "A_dft_hid_re": _A_in["dft_hid_re"],
        "A_dft_hid_im": _A_in["dft_hid_im"],
        "B_x": _B_in["x"],
        "B_w1": _B_in["w1"],
        "B_w2": _B_in["w2"],
    }

def reference(A_x, A_dft_seq_re, A_dft_seq_im, A_dft_hid_re, A_dft_hid_im, B_x, B_w1, B_w2):
    def _A_ref(x, dft_seq_re, dft_seq_im, dft_hid_re, dft_hid_im):
        a = torch.einsum("bsd,ed->bse", x, dft_hid_re)
        b = torch.einsum("bsd,ed->bse", x, dft_hid_im)
        y = torch.einsum("ts,bse->bte", dft_seq_re, a) - torch.einsum("ts,bse->bte", dft_seq_im, b)
        return y

    def _B_ref(x, w1, w2):
        h = torch.einsum("bsd,df->bsf", x, w1)
        zero = torch.zeros_like(h)
        h = torch.maximum(h, zero)
        return torch.einsum("bsf,fd->bsd", h, w2)

    x = A_x
    h = x + _A_ref(_layernorm(x, axis=-1), A_dft_seq_re, A_dft_seq_im, A_dft_hid_re, A_dft_hid_im)
    h2 = h + _B_ref(_layernorm(h, axis=-1), B_w1, B_w2)
    return h2
```

```asm
; @launch kernel=prep_kernel grid=(496,1,1) block=(256,1,1) lds=0
; @launch kernel=ga_kernel grid=(296,1,1) block=(512,1,1) lds=81920
; @launch kernel=gb_kernel grid=(312,1,1) block=(512,1,1) lds=81920
; @launch kernel=ln2_kernel grid=(512,1,1) block=(256,1,1) lds=0
; @launch kernel=g1_kernel grid=(256,1,1) block=(512,1,1) lds=135168
; @launch kernel=g2_kernel grid=(256,1,1) block=(512,1,1) lds=147456
.amdgcn_target "amdgcn-amd-amdhsa--gfx950"
.text
.globl prep_kernel
.p2align 8
.type prep_kernel,@function
prep_kernel:
    s_cmp_ge_u32 s2, 272
    s_cbranch_scc1 prep_stream
    s_load_dwordx2 s[4:5], s[0:1], 0
    s_load_dwordx2 s[6:7], s[0:1], 80
    v_lshrrev_b32 v1, 6, v0
    v_and_b32 v0, 63, v0
    v_readfirstlane_b32 s3, v1
    s_lshl_b32 s20, s2, 2
    s_add_u32 s20, s20, s3
    s_waitcnt lgkmcnt(0)
    s_mov_b32 s8, s4
    s_mov_b32 s9, s5
    s_mov_b32 s10, 4194304
    s_mov_b32 s11, 0x00020000
    s_mul_i32 s21, s20, 1152
    s_add_u32 s12, s6, s21
    s_addc_u32 s13, s7, 0
    s_mov_b32 s14, 1152
    s_mov_b32 s15, 0x00020000
    s_lshl_b32 s21, s20, 10
    s_add_u32 s21, s21, 2097152
    s_add_u32 s16, s6, s21
    s_addc_u32 s17, s7, 0
    s_mov_b32 s18, 1024
    s_mov_b32 s19, 0x00020000
    v_lshlrev_b32 v1, 4, v0
    s_cmp_ge_u32 s20, 1025
    s_cbranch_scc1 prep_zero
    s_sub_u32 s22, 2048, s20
    s_and_b32 s22, s22, 2047
    s_lshl_b32 s23, s20, 11
    s_lshl_b32 s24, s22, 11
    v_sub_u32 v2, 2032, v1
    v_sub_u32 v3, 2048, v1
    buffer_load_dwordx4 v[4:7], v1, s[8:11], s23 offen
    buffer_load_dwordx4 v[8:11], v2, s[8:11], s23 offen
    buffer_load_dwordx4 v[12:15], v1, s[8:11], s24 offen
    buffer_load_dwordx4 v[16:19], v2, s[8:11], s24 offen
    v_add_u32 v22, s23, v3
    v_add_u32 v23, s24, v3
    buffer_load_ushort v20, v22, s[8:11], 0 offen
    buffer_load_ushort v21, v23, s[8:11], 0 offen
    s_waitcnt vmcnt(0)
    v_and_b32 v25, 0xffff0000, v4
    v_lshlrev_b32 v24, 16, v4
    v_and_b32 v27, 0xffff0000, v5
    v_lshlrev_b32 v26, 16, v5
    v_and_b32 v29, 0xffff0000, v6
    v_lshlrev_b32 v28, 16, v6
    v_and_b32 v31, 0xffff0000, v7
    v_lshlrev_b32 v30, 16, v7
    v_and_b32 v33, 0xffff0000, v8
    v_lshlrev_b32 v32, 16, v8
    v_and_b32 v35, 0xffff0000, v9
    v_lshlrev_b32 v34, 16, v9
    v_and_b32 v37, 0xffff0000, v10
    v_lshlrev_b32 v36, 16, v10
    v_and_b32 v39, 0xffff0000, v11
    v_lshlrev_b32 v38, 16, v11
    v_and_b32 v41, 0xffff0000, v12
    v_lshlrev_b32 v40, 16, v12
    v_and_b32 v43, 0xffff0000, v13
    v_lshlrev_b32 v42, 16, v13
    v_and_b32 v45, 0xffff0000, v14
    v_lshlrev_b32 v44, 16, v14
    v_and_b32 v47, 0xffff0000, v15
    v_lshlrev_b32 v46, 16, v15
    v_and_b32 v49, 0xffff0000, v16
    v_lshlrev_b32 v48, 16, v16
    v_and_b32 v51, 0xffff0000, v17
    v_lshlrev_b32 v50, 16, v17
    v_and_b32 v53, 0xffff0000, v18
    v_lshlrev_b32 v52, 16, v18
    v_and_b32 v55, 0xffff0000, v19
    v_lshlrev_b32 v54, 16, v19
    v_lshlrev_b32 v20, 16, v20
    v_lshlrev_b32 v21, 16, v21
    v_add_f32 v56, v24, v25
    v_add_f32 v56, v56, v26
    v_add_f32 v56, v56, v27
    v_add_f32 v56, v56, v28
    v_add_f32 v56, v56, v29
    v_add_f32 v56, v56, v30
    v_add_f32 v56, v56, v31
    v_add_f32 v56, v56, v32
    v_add_f32 v56, v56, v33
    v_add_f32 v56, v56, v34
    v_add_f32 v56, v56, v35
    v_add_f32 v56, v56, v36
    v_add_f32 v56, v56, v37
    v_add_f32 v56, v56, v38
    v_add_f32 v56, v56, v39
    v_add_f32 v57, v40, v41
    v_add_f32 v57, v57, v42
    v_add_f32 v57, v57, v43
    v_add_f32 v57, v57, v44
    v_add_f32 v57, v57, v45
    v_add_f32 v57, v57, v46
    v_add_f32 v57, v57, v47
    v_add_f32 v57, v57, v48
    v_add_f32 v57, v57, v49
    v_add_f32 v57, v57, v50
    v_add_f32 v57, v57, v51
    v_add_f32 v57, v57, v52
    v_add_f32 v57, v57, v53
    v_add_f32 v57, v57, v54
    v_add_f32 v57, v57, v55
    s_nop 1
    v_add_f32_dpp v56, v56, v56 row_shr:1 row_mask:0xf bank_mask:0xf bound_ctrl:0
    v_add_f32_dpp v57, v57, v57 row_shr:1 row_mask:0xf bank_mask:0xf bound_ctrl:0
    s_nop 1
    v_add_f32_dpp v56, v56, v56 row_shr:2 row_mask:0xf bank_mask:0xf bound_ctrl:0
    v_add_f32_dpp v57, v57, v57 row_shr:2 row_mask:0xf bank_mask:0xf bound_ctrl:0
    s_nop 1
    v_add_f32_dpp v56, v56, v56 row_shr:4 row_mask:0xf bank_mask:0xf bound_ctrl:0
    v_add_f32_dpp v57, v57, v57 row_shr:4 row_mask:0xf bank_mask:0xf bound_ctrl:0
    s_nop 1
    v_add_f32_dpp v56, v56, v56 row_shr:8 row_mask:0xf bank_mask:0xf bound_ctrl:0
    v_add_f32_dpp v57, v57, v57 row_shr:8 row_mask:0xf bank_mask:0xf bound_ctrl:0
    s_nop 1
    v_add_f32_dpp v56, v56, v56 row_bcast:15 row_mask:0xa bank_mask:0xf
    v_add_f32_dpp v57, v57, v57 row_bcast:15 row_mask:0xa bank_mask:0xf
    s_nop 1
    v_add_f32_dpp v56, v56, v56 row_bcast:31 row_mask:0xc bank_mask:0xf
    v_add_f32_dpp v57, v57, v57 row_bcast:31 row_mask:0xc bank_mask:0xf
    s_nop 1
    v_readlane_b32 s26, v56, 63
    v_readlane_b32 s27, v57, 63
    s_nop 1
    v_mov_b32 v56, s26
    v_mul_f32 v56, 0x3a800000, v56
    v_mov_b32 v57, s27
    v_mul_f32 v57, 0x3a800000, v57
    v_sub_f32 v24, v24, v56
    v_sub_f32 v25, v25, v56
    v_sub_f32 v26, v26, v56
    v_sub_f32 v27, v27, v56
    v_sub_f32 v28, v28, v56
    v_sub_f32 v29, v29, v56
    v_sub_f32 v30, v30, v56
    v_sub_f32 v31, v31, v56
    v_sub_f32 v32, v32, v56
    v_sub_f32 v33, v33, v56
    v_sub_f32 v34, v34, v56
    v_sub_f32 v35, v35, v56
    v_sub_f32 v36, v36, v56
    v_sub_f32 v37, v37, v56
    v_sub_f32 v38, v38, v56
    v_sub_f32 v39, v39, v56
    v_sub_f32 v40, v40, v57
    v_sub_f32 v41, v41, v57
    v_sub_f32 v42, v42, v57
    v_sub_f32 v43, v43, v57
    v_sub_f32 v44, v44, v57
    v_sub_f32 v45, v45, v57
    v_sub_f32 v46, v46, v57
    v_sub_f32 v47, v47, v57
    v_sub_f32 v48, v48, v57
    v_sub_f32 v49, v49, v57
    v_sub_f32 v50, v50, v57
    v_sub_f32 v51, v51, v57
    v_sub_f32 v52, v52, v57
    v_sub_f32 v53, v53, v57
    v_sub_f32 v54, v54, v57
    v_sub_f32 v55, v55, v57
    v_mul_f32 v56, v24, v24
    v_fmac_f32 v56, v25, v25
    v_fmac_f32 v56, v26, v26
    v_fmac_f32 v56, v27, v27
    v_fmac_f32 v56, v28, v28
    v_fmac_f32 v56, v29, v29
    v_fmac_f32 v56, v30, v30
    v_fmac_f32 v56, v31, v31
    v_fmac_f32 v56, v32, v32
    v_fmac_f32 v56, v33, v33
    v_fmac_f32 v56, v34, v34
    v_fmac_f32 v56, v35, v35
    v_fmac_f32 v56, v36, v36
    v_fmac_f32 v56, v37, v37
    v_fmac_f32 v56, v38, v38
    v_fmac_f32 v56, v39, v39
    v_mul_f32 v57, v40, v40
    v_fmac_f32 v57, v41, v41
    v_fmac_f32 v57, v42, v42
    v_fmac_f32 v57, v43, v43
    v_fmac_f32 v57, v44, v44
    v_fmac_f32 v57, v45, v45
    v_fmac_f32 v57, v46, v46
    v_fmac_f32 v57, v47, v47
    v_fmac_f32 v57, v48, v48
    v_fmac_f32 v57, v49, v49
    v_fmac_f32 v57, v50, v50
    v_fmac_f32 v57, v51, v51
    v_fmac_f32 v57, v52, v52
    v_fmac_f32 v57, v53, v53
    v_fmac_f32 v57, v54, v54
    v_fmac_f32 v57, v55, v55
    s_nop 1
    v_add_f32_dpp v56, v56, v56 row_shr:1 row_mask:0xf bank_mask:0xf bound_ctrl:0
    v_add_f32_dpp v57, v57, v57 row_shr:1 row_mask:0xf bank_mask:0xf bound_ctrl:0
    s_nop 1
    v_add_f32_dpp v56, v56, v56 row_shr:2 row_mask:0xf bank_mask:0xf bound_ctrl:0
    v_add_f32_dpp v57, v57, v57 row_shr:2 row_mask:0xf bank_mask:0xf bound_ctrl:0
    s_nop 1
    v_add_f32_dpp v56, v56, v56 row_shr:4 row_mask:0xf bank_mask:0xf bound_ctrl:0
    v_add_f32_dpp v57, v57, v57 row_shr:4 row_mask:0xf bank_mask:0xf bound_ctrl:0
    s_nop 1
    v_add_f32_dpp v56, v56, v56 row_shr:8 row_mask:0xf bank_mask:0xf bound_ctrl:0
    v_add_f32_dpp v57, v57, v57 row_shr:8 row_mask:0xf bank_mask:0xf bound_ctrl:0
    s_nop 1
    v_add_f32_dpp v56, v56, v56 row_bcast:15 row_mask:0xa bank_mask:0xf
    v_add_f32_dpp v57, v57, v57 row_bcast:15 row_mask:0xa bank_mask:0xf
    s_nop 1
    v_add_f32_dpp v56, v56, v56 row_bcast:31 row_mask:0xc bank_mask:0xf
    v_add_f32_dpp v57, v57, v57 row_bcast:31 row_mask:0xc bank_mask:0xf
    s_nop 1
    v_readlane_b32 s28, v56, 63
    v_readlane_b32 s29, v57, 63
    s_nop 1
    v_mov_b32 v56, s28
    v_mul_f32 v56, 0x3a800000, v56
    v_add_f32 v56, 0x3727c5ac, v56
    v_rsq_f32 v56, v56
    v_mov_b32 v57, s29
    v_mul_f32 v57, 0x3a800000, v57
    v_add_f32 v57, 0x3727c5ac, v57
    v_rsq_f32 v57, v57
    s_nop 0
    v_mul_f32 v24, v24, v56
    v_mul_f32 v25, v25, v56
    v_mul_f32 v26, v26, v56
    v_mul_f32 v27, v27, v56
    v_mul_f32 v28, v28, v56
    v_mul_f32 v29, v29, v56
    v_mul_f32 v30, v30, v56
    v_mul_f32 v31, v31, v56
    v_mul_f32 v32, v32, v56
    v_mul_f32 v33, v33, v56
    v_mul_f32 v34, v34, v56
    v_mul_f32 v35, v35, v56
    v_mul_f32 v36, v36, v56
    v_mul_f32 v37, v37, v56
    v_mul_f32 v38, v38, v56
    v_mul_f32 v39, v39, v56
    v_mul_f32 v40, v40, v57
    v_mul_f32 v41, v41, v57
    v_mul_f32 v42, v42, v57
    v_mul_f32 v43, v43, v57
    v_mul_f32 v44, v44, v57
    v_mul_f32 v45, v45, v57
    v_mul_f32 v46, v46, v57
    v_mul_f32 v47, v47, v57
    v_mul_f32 v48, v48, v57
    v_mul_f32 v49, v49, v57
    v_mul_f32 v50, v50, v57
    v_mul_f32 v51, v51, v57
    v_mul_f32 v52, v52, v57
    v_mul_f32 v53, v53, v57
    v_mul_f32 v54, v54, v57
    v_mul_f32 v55, v55, v57
    v_mov_b32 v58, s26
    v_mul_f32 v58, 0x3a800000, v58
    v_sub_f32 v20, v20, v58
    v_mul_f32 v20, v20, v56
    v_mov_b32 v58, s27
    v_mul_f32 v58, 0x3a800000, v58
    v_sub_f32 v21, v21, v58
    v_mul_f32 v21, v21, v57
    v_cmp_eq_u32 vcc, 0, v0
    s_nop 1
    v_mov_b32 v58, 0
    v_cndmask_b32 v20, v20, v58, vcc
    v_cndmask_b32 v21, v21, v58, vcc
    s_cmp_eq_u32 s20, s22
    s_cselect_b32 s25, 0, 1.0
    v_add_f32 v76, v24, v20
    v_sub_f32 v77, v24, v20
    v_add_f32 v78, v40, v21
    v_sub_f32 v79, v40, v21
    v_fma_f32 v60, s25, v78, v76
    v_sub_f32 v68, v77, v79
    v_add_f32 v76, v25, v39
    v_sub_f32 v77, v25, v39
    v_add_f32 v78, v41, v55
    v_sub_f32 v79, v41, v55
    v_fma_f32 v61, s25, v78, v76
    v_sub_f32 v69, v77, v79
    v_add_f32 v76, v26, v38
    v_sub_f32 v77, v26, v38
    v_add_f32 v78, v42, v54
    v_sub_f32 v79, v42, v54
    v_fma_f32 v62, s25, v78, v76
    v_sub_f32 v70, v77, v79
    v_add_f32 v76, v27, v37
    v_sub_f32 v77, v27, v37
    v_add_f32 v78, v43, v53
    v_sub_f32 v79, v43, v53
    v_fma_f32 v63, s25, v78, v76
    v_sub_f32 v71, v77, v79
    v_add_f32 v76, v28, v36
    v_sub_f32 v77, v28, v36
    v_add_f32 v78, v44, v52
    v_sub_f32 v79, v44, v52
    v_fma_f32 v64, s25, v78, v76
    v_sub_f32 v72, v77, v79
    v_add_f32 v76, v29, v35
    v_sub_f32 v77, v29, v35
    v_add_f32 v78, v45, v51
    v_sub_f32 v79, v45, v51
    v_fma_f32 v65, s25, v78, v76
    v_sub_f32 v73, v77, v79
    v_add_f32 v76, v30, v34
    v_sub_f32 v77, v30, v34
    v_add_f32 v78, v46, v50
    v_sub_f32 v79, v46, v50
    v_fma_f32 v66, s25, v78, v76
    v_sub_f32 v74, v77, v79
    v_add_f32 v76, v31, v33
    v_sub_f32 v77, v31, v33
    v_add_f32 v78, v47, v49
    v_sub_f32 v79, v47, v49
    v_fma_f32 v67, s25, v78, v76
    v_sub_f32 v75, v77, v79
    v_cvt_pk_bf16_f32 v80, v60, v61
    v_cvt_pk_bf16_f32 v84, v68, v69
    v_cvt_pk_bf16_f32 v81, v62, v63
    v_cvt_pk_bf16_f32 v85, v70, v71
    v_cvt_pk_bf16_f32 v82, v64, v65
    v_cvt_pk_bf16_f32 v86, v72, v73
    v_cvt_pk_bf16_f32 v83, v66, v67
    v_cvt_pk_bf16_f32 v87, v74, v75
    buffer_store_dwordx4 v[80:83], v1, s[12:15], 0 offen
    s_cmp_ge_u32 s20, 1024
    s_cbranch_scc1 prep_noO
    buffer_store_dwordx4 v[84:87], v1, s[16:19], 0 offen
prep_noO:
    v_fma_f32 v76, s25, v48, v32
    s_nop 1
    v_readlane_b32 s28, v76, 63
    s_nop 1
    v_mov_b32 v76, s28
    v_cvt_pk_bf16_f32 v76, v76, v58
    v_cndmask_b32 v88, v58, v76, vcc
    v_mov_b32 v89, 0
    v_mov_b32 v90, 0
    v_mov_b32 v91, 0
    buffer_store_dwordx4 v[88:91], v1, s[12:15], 0 offen offset:1024
    s_endpgm
prep_zero:
    v_mov_b32 v4, 0
    v_mov_b32 v5, 0
    v_mov_b32 v6, 0
    v_mov_b32 v7, 0
    buffer_store_dwordx4 v[4:7], v1, s[12:15], 0 offen
    buffer_store_dwordx4 v[4:7], v1, s[12:15], 0 offen offset:1024
prep_end:
    s_endpgm
prep_stream:
    s_sub_u32 s2, s2, 272
    v_lshrrev_b32 v1, 6, v0
    v_and_b32 v0, 63, v0
    v_readfirstlane_b32 s3, v1
    v_lshlrev_b32 v0, 4, v0
    s_cmp_ge_u32 s2, 224
    s_cbranch_scc1 prep_st1
    s_load_dwordx2 s[4:5], s[0:1], 48
    s_mul_i32 s6, s2, 4
    s_add_u32 s6, s6, s3
    s_mul_i32 s6, s6, 8192
    s_waitcnt lgkmcnt(0)
    s_add_u32 s8, s4, s6
    s_addc_u32 s9, s5, 0
    s_sub_u32 s10, 7340032, s6
    s_cselect_b32 s10, 0, s10
    s_mov_b32 s11, 0x00020000
    s_mov_b32 s7, 0
    buffer_load_dwordx4 v[4:7], v0, s[8:11], s7 offen offset:0
    s_add_u32 s7, s7, 1024
    buffer_load_dwordx4 v[4:7], v0, s[8:11], s7 offen offset:0
    s_add_u32 s7, s7, 1024
    buffer_load_dwordx4 v[4:7], v0, s[8:11], s7 offen offset:0
    s_add_u32 s7, s7, 1024
    buffer_load_dwordx4 v[4:7], v0, s[8:11], s7 offen offset:0
    s_add_u32 s7, s7, 1024
    buffer_load_dwordx4 v[4:7], v0, s[8:11], s7 offen offset:0
    s_add_u32 s7, s7, 1024
    buffer_load_dwordx4 v[4:7], v0, s[8:11], s7 offen offset:0
    s_add_u32 s7, s7, 1024
    buffer_load_dwordx4 v[4:7], v0, s[8:11], s7 offen offset:0
    s_add_u32 s7, s7, 1024
    buffer_load_dwordx4 v[4:7], v0, s[8:11], s7 offen offset:0
    s_waitcnt vmcnt(0)
    s_endpgm
prep_st1:
    s_sub_u32 s2, s2, 224
    s_branch prep_end
.globl ga_kernel
.p2align 8
.type ga_kernel,@function
ga_kernel:
    s_cmp_ge_u32 s2, 208
    s_cbranch_scc1 ga_stream
    s_load_dwordx2 s[40:41], s[0:1], 80
    s_lshr_b32 s51, s2, 3
    s_and_b32 s50, s2, 3
    s_bitcmp1_b32 s2, 2
    s_cbranch_scc1 ga_p1
    s_cmp_ge_u32 s51, 26
    s_cbranch_scc1 ga_end
    s_mul_i32 s2, s50, 26
    s_add_u32 s2, s2, s51
    s_cmp_ge_u32 s2, 102
    s_cbranch_scc1 ga_end
    s_load_dwordx2 s[4:5], s[0:1], 24
    s_mul_i32 s50, s2, 3856
    s_lshr_b32 s50, s50, 16
    s_mul_i32 s51, s50, 17
    s_sub_u32 s51, s2, s51
    s_mov_b32 s31, 2048
    s_mov_b32 s32, 1152
    s_mov_b32 s33, 2176
    s_mov_b32 s24, 9
    s_waitcnt lgkmcnt(0)
    s_mul_i32 s52, s50, 196608
    s_sub_u32 s42, 2097152, s52
    s_add_u32 s4, s4, s52
    s_addc_u32 s5, s5, 0
    s_mul_i32 s52, s51, 73728
    s_sub_u32 s43, 1253376, s52
    s_add_u32 s52, s52, 0
    s_add_u32 s6, s40, s52
    s_addc_u32 s7, s41, 0
    s_mul_i32 s52, s50, 208896
    s_mul_i32 s53, s51, 128
    s_add_u32 s52, s52, s53
    s_sub_u32 s44, 1253376, s52
    s_add_u32 s52, s52, 4194304
    s_add_u32 s36, s40, s52
    s_addc_u32 s37, s41, 0
    s_branch ga_go
ga_p1:
    s_cmp_ge_u32 s51, 24
    s_cbranch_scc1 ga_end
    s_mul_i32 s2, s50, 24
    s_add_u32 s2, s2, s51
    s_cmp_ge_u32 s2, 96
    s_cbranch_scc1 ga_end
    s_load_dwordx2 s[4:5], s[0:1], 32
    s_mul_i32 s50, s2, 4096
    s_lshr_b32 s50, s50, 16
    s_mul_i32 s51, s50, 16
    s_sub_u32 s51, s2, s51
    s_mov_b32 s31, 2048
    s_mov_b32 s32, 1024
    s_mov_b32 s33, 2048
    s_mov_b32 s24, 8
    s_waitcnt lgkmcnt(0)
    s_mul_i32 s52, s50, 196608
    s_sub_u32 s42, 2097152, s52
    s_add_u32 s4, s4, s52
    s_addc_u32 s5, s5, 0
    s_mul_i32 s52, s51, 65536
    s_sub_u32 s43, 1048576, s52
    s_add_u32 s52, s52, 2097152
    s_add_u32 s6, s40, s52
    s_addc_u32 s7, s41, 0
    s_mul_i32 s52, s50, 196608
    s_mul_i32 s53, s51, 128
    s_add_u32 s52, s52, s53
    s_sub_u32 s44, 1179648, s52
    s_add_u32 s52, s52, 6291456
    s_add_u32 s36, s40, s52
    s_addc_u32 s37, s41, 0
ga_go:
    s_mov_b32 s8, s4
    s_mov_b32 s9, s5
    s_mov_b32 s10, s42
    s_mov_b32 s11, 0x00020000
    s_mov_b32 s12, s6
    s_mov_b32 s13, s7
    s_mov_b32 s14, s43
    s_mov_b32 s15, 0x00020000
    s_mov_b32 s16, s36
    s_mov_b32 s17, s37
    s_mov_b32 s18, s44
    s_mov_b32 s19, 0x00020000
    v_lshrrev_b32 v14, 6, v0
    v_and_b32 v0, 63, v0
    v_readfirstlane_b32 s29, v14
    s_nop 3
    s_cmp_lt_u32 s29, 4
    s_cbranch_scc1 ga_compute
    s_sub_u32 s29, s29, 4
    v_subrev_u32 v14, 4, v14
    s_setprio 2
    v_lshrrev_b32 v15, 3, v0
    v_lshl_add_u32 v15, v14, 3, v15
    v_bfe_u32 v16, v15, 1, 3
    v_and_b32 v17, 7, v0
    v_xor_b32 v16, v16, v17
    v_lshlrev_b32 v16, 4, v16
    v_mul_lo_u32 v17, v15, s31
    v_add_u32 v1, v17, v16
    s_lshl_b32 s45, s31, 5
    v_add_u32 v2, s45, v1
    v_add_u32 v3, s45, v2
    v_mul_lo_u32 v17, v15, s32
    v_add_u32 v4, v17, v16
    s_lshl_b32 s45, s32, 5
    v_add_u32 v5, s45, v4
    s_movk_i32 s34, 128
    s_mov_b32 s25, 0
    s_mov_b32 s26, 0
    s_lshl_b32 s27, s29, 10
    s_add_u32 s48, s27, 81920
    s_mov_b32 m0, s27
    s_nop 0
    buffer_load_dwordx4 v1, s[8:11], s25 offen lds
    s_add_u32 m0, m0, 0x1000
    s_nop 0
    buffer_load_dwordx4 v2, s[8:11], s25 offen lds
    s_add_u32 m0, m0, 0x1000
    s_nop 0
    buffer_load_dwordx4 v3, s[8:11], s25 offen lds
    s_add_u32 m0, m0, 0x1000
    s_nop 0
    buffer_load_dwordx4 v4, s[12:15], s26 offen lds
    s_add_u32 m0, m0, 0x1000
    s_nop 0
    buffer_load_dwordx4 v5, s[12:15], s26 offen lds
    s_add_u32 s25, s25, 128
    s_add_u32 s26, s26, s34
    s_add_u32 s27, s27, 20480
    s_cmp_ge_u32 s27, s48
    s_cselect_b32 s49, 81920, 0
    s_sub_u32 s27, s27, s49
    s_mov_b32 m0, s27
    s_nop 0
    buffer_load_dwordx4 v1, s[8:11], s25 offen lds
    s_add_u32 m0, m0, 0x1000
    s_nop 0
    buffer_load_dwordx4 v2, s[8:11], s25 offen lds
    s_add_u32 m0, m0, 0x1000
    s_nop 0
    buffer_load_dwordx4 v3, s[8:11], s25 offen lds
    s_add_u32 m0, m0, 0x1000
    s_nop 0
    buffer_load_dwordx4 v4, s[12:15], s26 offen lds
    s_add_u32 m0, m0, 0x1000
    s_nop 0
    buffer_load_dwordx4 v5, s[12:15], s26 offen lds
    s_add_u32 s25, s25, 128
    s_add_u32 s26, s26, s34
    s_add_u32 s27, s27, 20480
    s_cmp_ge_u32 s27, s48
    s_cselect_b32 s49, 81920, 0
    s_sub_u32 s27, s27, s49
    s_mov_b32 m0, s27
    s_nop 0
    buffer_load_dwordx4 v1, s[8:11], s25 offen lds
    s_add_u32 m0, m0, 0x1000
    s_nop 0
    buffer_load_dwordx4 v2, s[8:11], s25 offen lds
    s_add_u32 m0, m0, 0x1000
    s_nop 0
    buffer_load_dwordx4 v3, s[8:11], s25 offen lds
    s_add_u32 m0, m0, 0x1000
    s_nop 0
    buffer_load_dwordx4 v4, s[12:15], s26 offen lds
    s_add_u32 m0, m0, 0x1000
    s_nop 0
    buffer_load_dwordx4 v5, s[12:15], s26 offen lds
    s_add_u32 s25, s25, 128
    s_add_u32 s26, s26, s34
    s_add_u32 s27, s27, 20480
    s_cmp_ge_u32 s27, s48
    s_cselect_b32 s49, 81920, 0
    s_sub_u32 s27, s27, s49
    s_mov_b32 m0, s27
    s_nop 0
    buffer_load_dwordx4 v1, s[8:11], s25 offen lds
    s_add_u32 m0, m0, 0x1000
    s_nop 0
    buffer_load_dwordx4 v2, s[8:11], s25 offen lds
    s_add_u32 m0, m0, 0x1000
    s_nop 0
    buffer_load_dwordx4 v3, s[8:11], s25 offen lds
    s_add_u32 m0, m0, 0x1000
    s_nop 0
    buffer_load_dwordx4 v4, s[12:15], s26 offen lds
    s_add_u32 m0, m0, 0x1000
    s_nop 0
    buffer_load_dwordx4 v5, s[12:15], s26 offen lds
    s_add_u32 s25, s25, 128
    s_add_u32 s26, s26, s34
    s_add_u32 s27, s27, 20480
    s_cmp_ge_u32 s27, s48
    s_cselect_b32 s49, 81920, 0
    s_sub_u32 s27, s27, s49
    s_waitcnt vmcnt(15)
    s_barrier
    s_sub_u32 s24, s24, 4
    s_cmp_eq_u32 s24, 0
    s_cbranch_scc1 ga_ltail
ga_lloop:
    s_waitcnt vmcnt(10)
    s_barrier
    s_mov_b32 m0, s27
    s_nop 0
    buffer_load_dwordx4 v1, s[8:11], s25 offen lds
    s_add_u32 m0, m0, 0x1000
    s_nop 0
    buffer_load_dwordx4 v2, s[8:11], s25 offen lds
    s_add_u32 m0, m0, 0x1000
    s_nop 0
    buffer_load_dwordx4 v3, s[8:11], s25 offen lds
    s_add_u32 m0, m0, 0x1000
    s_nop 0
    buffer_load_dwordx4 v4, s[12:15], s26 offen lds
    s_add_u32 m0, m0, 0x1000
    s_nop 0
    buffer_load_dwordx4 v5, s[12:15], s26 offen lds
    s_add_u32 s25, s25, 128
    s_add_u32 s26, s26, s34
    s_add_u32 s27, s27, 20480
    s_cmp_ge_u32 s27, s48
    s_cselect_b32 s49, 81920, 0
    s_sub_u32 s27, s27, s49
    s_sub_u32 s24, s24, 1
    s_cmp_lg_u32 s24, 0
    s_cbranch_scc1 ga_lloop
ga_ltail:
    s_waitcnt vmcnt(10)
    s_barrier
    s_waitcnt vmcnt(5)
    s_barrier
    s_waitcnt vmcnt(0)
    s_barrier
    s_endpgm
ga_compute:
    s_movk_i32 s84, 128
    s_lshr_b32 s46, s29, 1
    s_and_b32 s47, s29, 1
    v_and_b32 v15, 15, v0
    v_lshrrev_b32 v16, 4, v0
    v_lshrrev_b32 v17, 1, v15
    v_xor_b32 v17, v17, v16
    v_lshlrev_b32 v17, 4, v17
    v_lshl_add_u32 v17, v15, 7, v17
    s_mul_i32 s45, s46, 6144
    v_add_u32 v6, s45, v17
    v_xor_b32 v7, 64, v6
    s_mul_i32 s45, s47, 4096
    s_add_u32 s45, s45, 12288
    v_add_u32 v8, s45, v17
    v_xor_b32 v9, 64, v8
    s_mul_i32 s45, s46, 48
    v_add_u32 v15, s45, v15
    v_mul_lo_u32 v22, v15, s33
    s_mul_i32 s45, s47, 64
    v_lshlrev_b32 v16, 3, v16
    v_add3_u32 v22, v22, v16, s45
    v_sub_u32 v24, v22, v16
    v_bfe_u32 v17, v0, 4, 1
    v_lshl_add_u32 v24, v17, 5, v24
    v_lshrrev_b32 v17, 5, v0
    v_lshl_add_u32 v24, v17, 4, v24
    v_mov_b32 v68, 0
    v_mov_b32 v69, 0
    v_mov_b32 v70, 0
    v_mov_b32 v71, 0
    v_mov_b32 v72, 0
    v_mov_b32 v73, 0
    v_mov_b32 v74, 0
    v_mov_b32 v75, 0
    v_mov_b32 v76, 0
    v_mov_b32 v77, 0
    v_mov_b32 v78, 0
    v_mov_b32 v79, 0
    v_mov_b32 v80, 0
    v_mov_b32 v81, 0
    v_mov_b32 v82, 0
    v_mov_b32 v83, 0
    v_mov_b32 v84, 0
    v_mov_b32 v85, 0
    v_mov_b32 v86, 0
    v_mov_b32 v87, 0
    v_mov_b32 v88, 0
    v_mov_b32 v89, 0
    v_mov_b32 v90, 0
    v_mov_b32 v91, 0
    s_mov_b32 s28, 0
    s_barrier
    v_add_u32 v10, s28, v6
    v_add_u32 v11, s28, v7
    v_add_u32 v12, s28, v8
    v_add_u32 v13, s28, v9
    s_add_u32 s28, s28, 20480
    s_cmp_ge_u32 s28, 81920
    s_cselect_b32 s49, 81920, 0
    s_sub_u32 s28, s28, s49
    ds_read_b128 v[28:31], v10 offset:0
    ds_read_b128 v[32:35], v10 offset:2048
    ds_read_b128 v[36:39], v10 offset:4096
    ds_read_b128 v[52:55], v12 offset:0
    ds_read_b128 v[56:59], v12 offset:2048
    s_sub_u32 s24, s24, 1
ga_loop:
    s_waitcnt lgkmcnt(0)
    v_mfma_f32_16x16x32_bf16 v[68:71], v[52:55], v[28:31], v[68:71]
    ds_read_b128 v[40:43], v11 offset:0
    ds_read_b128 v[44:47], v11 offset:2048
    v_mfma_f32_16x16x32_bf16 v[76:79], v[52:55], v[32:35], v[76:79]
    ds_read_b128 v[48:51], v11 offset:4096
    ds_read_b128 v[60:63], v13 offset:0
    v_mfma_f32_16x16x32_bf16 v[84:87], v[52:55], v[36:39], v[84:87]
    ds_read_b128 v[64:67], v13 offset:2048
    v_mfma_f32_16x16x32_bf16 v[72:75], v[56:59], v[28:31], v[72:75]
    v_mfma_f32_16x16x32_bf16 v[80:83], v[56:59], v[32:35], v[80:83]
    v_mfma_f32_16x16x32_bf16 v[88:91], v[56:59], v[36:39], v[88:91]
    s_waitcnt lgkmcnt(0)
    s_barrier
    v_add_u32 v10, s28, v6
    v_add_u32 v11, s28, v7
    v_add_u32 v12, s28, v8
    v_add_u32 v13, s28, v9
    v_mfma_f32_16x16x32_bf16 v[68:71], v[60:63], v[40:43], v[68:71]
    ds_read_b128 v[28:31], v10 offset:0
    ds_read_b128 v[32:35], v10 offset:2048
    v_mfma_f32_16x16x32_bf16 v[76:79], v[60:63], v[44:47], v[76:79]
    ds_read_b128 v[36:39], v10 offset:4096
    ds_read_b128 v[52:55], v12 offset:0
    v_mfma_f32_16x16x32_bf16 v[84:87], v[60:63], v[48:51], v[84:87]
    ds_read_b128 v[56:59], v12 offset:2048
    s_add_u32 s28, s28, 20480
    v_mfma_f32_16x16x32_bf16 v[72:75], v[64:67], v[40:43], v[72:75]
    s_cmp_ge_u32 s28, 81920
    s_cselect_b32 s49, 81920, 0
    v_mfma_f32_16x16x32_bf16 v[80:83], v[64:67], v[44:47], v[80:83]
    s_sub_u32 s28, s28, s49
    v_mfma_f32_16x16x32_bf16 v[88:91], v[64:67], v[48:51], v[88:91]
    s_sub_u32 s24, s24, 1
    s_cmp_lg_u32 s24, 0
    s_cbranch_scc1 ga_loop
    s_waitcnt lgkmcnt(0)
    v_mfma_f32_16x16x32_bf16 v[68:71], v[52:55], v[28:31], v[68:71]
    ds_read_b128 v[40:43], v11 offset:0
    ds_read_b128 v[44:47], v11 offset:2048
    v_mfma_f32_16x16x32_bf16 v[76:79], v[52:55], v[32:35], v[76:79]
    ds_read_b128 v[48:51], v11 offset:4096
    ds_read_b128 v[60:63], v13 offset:0
    v_mfma_f32_16x16x32_bf16 v[84:87], v[52:55], v[36:39], v[84:87]
    ds_read_b128 v[64:67], v13 offset:2048
    v_mfma_f32_16x16x32_bf16 v[72:75], v[56:59], v[28:31], v[72:75]
    v_mfma_f32_16x16x32_bf16 v[80:83], v[56:59], v[32:35], v[80:83]
    v_mfma_f32_16x16x32_bf16 v[88:91], v[56:59], v[36:39], v[88:91]
    s_waitcnt lgkmcnt(0)
    v_mfma_f32_16x16x32_bf16 v[68:71], v[60:63], v[40:43], v[68:71]
    v_mfma_f32_16x16x32_bf16 v[76:79], v[60:63], v[44:47], v[76:79]
    v_mfma_f32_16x16x32_bf16 v[84:87], v[60:63], v[48:51], v[84:87]
    v_mfma_f32_16x16x32_bf16 v[72:75], v[64:67], v[40:43], v[72:75]
    v_mfma_f32_16x16x32_bf16 v[80:83], v[64:67], v[44:47], v[80:83]
    v_mfma_f32_16x16x32_bf16 v[88:91], v[64:67], v[48:51], v[88:91]
    s_nop 7
    s_nop 1
    s_lshl_b32 s45, s33, 4
    s_mov_b32 s46, 0
    v_cvt_pk_bf16_f32 v68, v68, v69
    v_cvt_pk_bf16_f32 v69, v70, v71
    v_cvt_pk_bf16_f32 v70, v72, v73
    v_cvt_pk_bf16_f32 v71, v74, v75
    s_nop 1
    v_permlane16_swap_b32 v68, v70
    v_permlane16_swap_b32 v69, v71
    buffer_store_dwordx4 v[68:71], v24, s[16:19], s46 offen offset:0
    s_add_u32 s46, s46, s45
    v_cvt_pk_bf16_f32 v76, v76, v77
    v_cvt_pk_bf16_f32 v77, v78, v79
    v_cvt_pk_bf16_f32 v78, v80, v81
    v_cvt_pk_bf16_f32 v79, v82, v83
    s_nop 1
    v_permlane16_swap_b32 v76, v78
    v_permlane16_swap_b32 v77, v79
    buffer_store_dwordx4 v[76:79], v24, s[16:19], s46 offen offset:0
    s_add_u32 s46, s46, s45
    v_cvt_pk_bf16_f32 v84, v84, v85
    v_cvt_pk_bf16_f32 v85, v86, v87
    v_cvt_pk_bf16_f32 v86, v88, v89
    v_cvt_pk_bf16_f32 v87, v90, v91
    s_nop 1
    v_permlane16_swap_b32 v84, v86
    v_permlane16_swap_b32 v85, v87
    buffer_store_dwordx4 v[84:87], v24, s[16:19], s46 offen offset:0
    s_add_u32 s46, s46, s45
ga_end:
    s_endpgm
ga_stream:
    s_sub_u32 s2, s2, 208
    v_lshrrev_b32 v1, 6, v0
    v_and_b32 v0, 63, v0
    v_readfirstlane_b32 s3, v1
    v_lshlrev_b32 v0, 4, v0
    s_cmp_ge_u32 s2, 44
    s_cbranch_scc1 ga_st1
    s_load_dwordx2 s[4:5], s[0:1], 8
    s_mul_i32 s6, s2, 8
    s_add_u32 s6, s6, s3
    s_mul_i32 s6, s6, 12288
    s_waitcnt lgkmcnt(0)
    s_add_u32 s8, s4, s6
    s_addc_u32 s9, s5, 0
    s_sub_u32 s10, 8388608, s6
    s_cselect_b32 s10, 0, s10
    s_mov_b32 s11, 0x00020000
    s_mov_b32 s7, 0
    buffer_load_dwordx4 v[4:7], v0, s[8:11], s7 offen offset:0
    buffer_load_dwordx4 v[4:7], v0, s[8:11], s7 offen offset:1024
    buffer_load_dwordx4 v[4:7], v0, s[8:11], s7 offen offset:2048
    s_add_u32 s7, s7, 4096
    buffer_load_dwordx4 v[4:7], v0, s[8:11], s7 offen offset:0
    buffer_load_dwordx4 v[4:7], v0, s[8:11], s7 offen offset:1024
    buffer_load_dwordx4 v[4:7], v0, s[8:11], s7 offen offset:2048
    s_add_u32 s7, s7, 4096
    buffer_load_dwordx4 v[4:7], v0, s[8:11], s7 offen offset:0
    buffer_load_dwordx4 v[4:7], v0, s[8:11], s7 offen offset:1024
    buffer_load_dwordx4 v[4:7], v0, s[8:11], s7 offen offset:2048
    s_waitcnt vmcnt(0)
    s_endpgm
ga_st1:
    s_sub_u32 s2, s2, 44
    s_cmp_ge_u32 s2, 44
    s_cbranch_scc1 ga_st2
    s_load_dwordx2 s[4:5], s[0:1], 16
    s_mul_i32 s6, s2, 8
    s_add_u32 s6, s6, s3
    s_mul_i32 s6, s6, 12288
    s_waitcnt lgkmcnt(0)
    s_add_u32 s8, s4, s6
    s_addc_u32 s9, s5, 0
    s_sub_u32 s10, 8388608, s6
    s_cselect_b32 s10, 0, s10
    s_mov_b32 s11, 0x00020000
    s_mov_b32 s7, 0
    buffer_load_dwordx4 v[4:7], v0, s[8:11], s7 offen offset:0
    buffer_load_dwordx4 v[4:7], v0, s[8:11], s7 offen offset:1024
    s_add_u32 s7, s7, 4096
    buffer_load_dwordx4 v[4:7], v0, s[8:11], s7 offen offset:0
    buffer_load_dwordx4 v[4:7], v0, s[8:11], s7 offen offset:1024
    s_add_u32 s7, s7, 4096
    buffer_load_dwordx4 v[4:7], v0, s[8:11], s7 offen offset:0
    buffer_load_dwordx4 v[4:7], v0, s[8:11], s7 offen offset:1024
    s_waitcnt vmcnt(0)
    s_endpgm
ga_st2:
    s_sub_u32 s2, s2, 44
    s_branch ga_end
.globl gb_kernel
.p2align 8
.type gb_kernel,@function
gb_kernel:
    s_cmp_ge_u32 s2, 200
    s_cbranch_scc1 gb_stream
    s_load_dwordx2 s[40:41], s[0:1], 80
    s_lshr_b32 s51, s2, 3
    s_and_b32 s50, s2, 3
    s_bitcmp1_b32 s2, 2
    s_cbranch_scc1 gb_p1
    s_cmp_ge_u32 s51, 25
    s_cbranch_scc1 gb_end
    s_mul_i32 s2, s50, 25
    s_add_u32 s2, s2, s51
    s_cmp_ge_u32 s2, 99
    s_cbranch_scc1 gb_end
    s_load_dwordx2 s[4:5], s[0:1], 8
    s_mul_i32 s50, s2, 7282
    s_lshr_b32 s50, s50, 16
    s_mul_i32 s51, s50, 9
    s_sub_u32 s51, s2, s51
    s_mov_b32 s31, 4096
    s_mov_b32 s32, 2176
    s_mov_b32 s33, 2304
    s_mov_b32 s24, 17
    s_waitcnt lgkmcnt(0)
    s_mul_i32 s52, s50, 393216
    s_sub_u32 s42, 8388608, s52
    s_add_u32 s4, s4, s52
    s_addc_u32 s5, s5, 0
    s_mul_i32 s52, s51, 139264
    s_sub_u32 s43, 1253376, s52
    s_add_u32 s52, s52, 4194304
    s_add_u32 s6, s40, s52
    s_addc_u32 s7, s41, 0
    s_mul_i32 s52, s50, 221184
    s_mul_i32 s53, s51, 256
    s_add_u32 s52, s52, s53
    s_sub_u32 s44, 2433024, s52
    s_add_u32 s52, s52, 8388608
    s_add_u32 s36, s40, s52
    s_addc_u32 s37, s41, 0
    s_branch gb_go
gb_p1:
    s_cmp_ge_u32 s51, 22
    s_cbranch_scc1 gb_end
    s_mul_i32 s2, s50, 22
    s_add_u32 s2, s2, s51
    s_cmp_ge_u32 s2, 88
    s_cbranch_scc1 gb_end
    s_load_dwordx2 s[4:5], s[0:1], 16
    s_mul_i32 s50, s2, 8192
    s_lshr_b32 s50, s50, 16
    s_mul_i32 s51, s50, 8
    s_sub_u32 s51, s2, s51
    s_mov_b32 s31, 4096
    s_mov_b32 s32, 2048
    s_mov_b32 s33, 2048
    s_mov_b32 s24, 16
    s_waitcnt lgkmcnt(0)
    s_mul_i32 s52, s50, 393216
    s_sub_u32 s42, 8388608, s52
    s_add_u32 s4, s4, s52
    s_addc_u32 s5, s5, 0
    s_mul_i32 s52, s51, 131072
    s_sub_u32 s43, 1179648, s52
    s_add_u32 s52, s52, 6291456
    s_add_u32 s6, s40, s52
    s_addc_u32 s7, s41, 0
    s_mul_i32 s52, s50, 196608
    s_mul_i32 s53, s51, 256
    s_add_u32 s52, s52, s53
    s_sub_u32 s44, 2162688, s52
    s_add_u32 s52, s52, 12582912
    s_add_u32 s36, s40, s52
    s_addc_u32 s37, s41, 0
gb_go:
    s_mov_b32 s8, s4
    s_mov_b32 s9, s5
    s_mov_b32 s10, s42
    s_mov_b32 s11, 0x00020000
    s_mov_b32 s12, s6
    s_mov_b32 s13, s7
    s_mov_b32 s14, s43
    s_mov_b32 s15, 0x00020000
    s_mov_b32 s16, s36
    s_mov_b32 s17, s37
    s_mov_b32 s18, s44
    s_mov_b32 s19, 0x00020000
    v_lshrrev_b32 v14, 6, v0
    v_and_b32 v0, 63, v0
    v_readfirstlane_b32 s29, v14
    s_nop 3
    s_cmp_lt_u32 s29, 4
    s_cbranch_scc1 gb_compute
    s_sub_u32 s29, s29, 4
    v_subrev_u32 v14, 4, v14
    s_setprio 2
    v_lshrrev_b32 v15, 3, v0
    v_lshl_add_u32 v15, v14, 3, v15
    v_bfe_u32 v16, v15, 1, 3
    v_and_b32 v17, 7, v0
    v_xor_b32 v16, v16, v17
    v_lshlrev_b32 v16, 4, v16
    v_mul_lo_u32 v17, v15, s31
    v_add_u32 v1, v17, v16
    s_lshl_b32 s45, s31, 5
    v_add_u32 v2, s45, v1
    v_add_u32 v3, s45, v2
    v_mul_lo_u32 v17, v15, s32
    v_add_u32 v4, v17, v16
    s_lshl_b32 s45, s32, 5
    v_add_u32 v5, s45, v4
    s_movk_i32 s34, 128
    s_mov_b32 s25, 0
    s_mov_b32 s26, 0
    s_lshl_b32 s27, s29, 10
    s_add_u32 s48, s27, 81920
    s_mov_b32 m0, s27
    s_nop 0
    buffer_load_dwordx4 v1, s[8:11], s25 offen lds
    s_add_u32 m0, m0, 0x1000
    s_nop 0
    buffer_load_dwordx4 v2, s[8:11], s25 offen lds
    s_add_u32 m0, m0, 0x1000
    s_nop 0
    buffer_load_dwordx4 v3, s[8:11], s25 offen lds
    s_add_u32 m0, m0, 0x1000
    s_nop 0
    buffer_load_dwordx4 v4, s[12:15], s26 offen lds
    s_add_u32 m0, m0, 0x1000
    s_nop 0
    buffer_load_dwordx4 v5, s[12:15], s26 offen lds
    s_add_u32 s25, s25, 128
    s_add_u32 s26, s26, s34
    s_add_u32 s27, s27, 20480
    s_cmp_ge_u32 s27, s48
    s_cselect_b32 s49, 81920, 0
    s_sub_u32 s27, s27, s49
    s_mov_b32 m0, s27
    s_nop 0
    buffer_load_dwordx4 v1, s[8:11], s25 offen lds
    s_add_u32 m0, m0, 0x1000
    s_nop 0
    buffer_load_dwordx4 v2, s[8:11], s25 offen lds
    s_add_u32 m0, m0, 0x1000
    s_nop 0
    buffer_load_dwordx4 v3, s[8:11], s25 offen lds
    s_add_u32 m0, m0, 0x1000
    s_nop 0
    buffer_load_dwordx4 v4, s[12:15], s26 offen lds
    s_add_u32 m0, m0, 0x1000
    s_nop 0
    buffer_load_dwordx4 v5, s[12:15], s26 offen lds
    s_add_u32 s25, s25, 128
    s_add_u32 s26, s26, s34
    s_add_u32 s27, s27, 20480
    s_cmp_ge_u32 s27, s48
    s_cselect_b32 s49, 81920, 0
    s_sub_u32 s27, s27, s49
    s_mov_b32 m0, s27
    s_nop 0
    buffer_load_dwordx4 v1, s[8:11], s25 offen lds
    s_add_u32 m0, m0, 0x1000
    s_nop 0
    buffer_load_dwordx4 v2, s[8:11], s25 offen lds
    s_add_u32 m0, m0, 0x1000
    s_nop 0
    buffer_load_dwordx4 v3, s[8:11], s25 offen lds
    s_add_u32 m0, m0, 0x1000
    s_nop 0
    buffer_load_dwordx4 v4, s[12:15], s26 offen lds
    s_add_u32 m0, m0, 0x1000
    s_nop 0
    buffer_load_dwordx4 v5, s[12:15], s26 offen lds
    s_add_u32 s25, s25, 128
    s_add_u32 s26, s26, s34
    s_add_u32 s27, s27, 20480
    s_cmp_ge_u32 s27, s48
    s_cselect_b32 s49, 81920, 0
    s_sub_u32 s27, s27, s49
    s_mov_b32 m0, s27
    s_nop 0
    buffer_load_dwordx4 v1, s[8:11], s25 offen lds
    s_add_u32 m0, m0, 0x1000
    s_nop 0
    buffer_load_dwordx4 v2, s[8:11], s25 offen lds
    s_add_u32 m0, m0, 0x1000
    s_nop 0
    buffer_load_dwordx4 v3, s[8:11], s25 offen lds
    s_add_u32 m0, m0, 0x1000
    s_nop 0
    buffer_load_dwordx4 v4, s[12:15], s26 offen lds
    s_add_u32 m0, m0, 0x1000
    s_nop 0
    buffer_load_dwordx4 v5, s[12:15], s26 offen lds
    s_add_u32 s25, s25, 128
    s_add_u32 s26, s26, s34
    s_add_u32 s27, s27, 20480
    s_cmp_ge_u32 s27, s48
    s_cselect_b32 s49, 81920, 0
    s_sub_u32 s27, s27, s49
    s_waitcnt vmcnt(15)
    s_barrier
    s_sub_u32 s24, s24, 4
    s_cmp_eq_u32 s24, 0
    s_cbranch_scc1 gb_ltail
gb_lloop:
    s_waitcnt vmcnt(10)
    s_barrier
    s_mov_b32 m0, s27
    s_nop 0
    buffer_load_dwordx4 v1, s[8:11], s25 offen lds
    s_add_u32 m0, m0, 0x1000
    s_nop 0
    buffer_load_dwordx4 v2, s[8:11], s25 offen lds
    s_add_u32 m0, m0, 0x1000
    s_nop 0
    buffer_load_dwordx4 v3, s[8:11], s25 offen lds
    s_add_u32 m0, m0, 0x1000
    s_nop 0
    buffer_load_dwordx4 v4, s[12:15], s26 offen lds
    s_add_u32 m0, m0, 0x1000
    s_nop 0
    buffer_load_dwordx4 v5, s[12:15], s26 offen lds
    s_add_u32 s25, s25, 128
    s_add_u32 s26, s26, s34
    s_add_u32 s27, s27, 20480
    s_cmp_ge_u32 s27, s48
    s_cselect_b32 s49, 81920, 0
    s_sub_u32 s27, s27, s49
    s_sub_u32 s24, s24, 1
    s_cmp_lg_u32 s24, 0
    s_cbranch_scc1 gb_lloop
gb_ltail:
    s_waitcnt vmcnt(10)
    s_barrier
    s_waitcnt vmcnt(5)
    s_barrier
    s_waitcnt vmcnt(0)
    s_barrier
    s_endpgm
gb_compute:
    s_movk_i32 s84, 128
    s_lshr_b32 s46, s29, 1
    s_and_b32 s47, s29, 1
    v_and_b32 v15, 15, v0
    v_lshrrev_b32 v16, 4, v0
    v_lshrrev_b32 v17, 1, v15
    v_xor_b32 v17, v17, v16
    v_lshlrev_b32 v17, 4, v17
    v_lshl_add_u32 v17, v15, 7, v17
    s_mul_i32 s45, s46, 6144
    v_add_u32 v6, s45, v17
    v_xor_b32 v7, 64, v6
    s_mul_i32 s45, s47, 4096
    s_add_u32 s45, s45, 12288
    v_add_u32 v8, s45, v17
    v_xor_b32 v9, 64, v8
    s_mul_i32 s45, s46, 48
    v_add_u32 v15, s45, v15
    v_mul_lo_u32 v22, v15, s33
    s_mul_i32 s45, s47, 128
    v_lshlrev_b32 v16, 4, v16
    v_add3_u32 v22, v22, v16, s45
    v_mov_b32 v68, 0
    v_mov_b32 v69, 0
    v_mov_b32 v70, 0
    v_mov_b32 v71, 0
    v_mov_b32 v72, 0
    v_mov_b32 v73, 0
    v_mov_b32 v74, 0
    v_mov_b32 v75, 0
    v_mov_b32 v76, 0
    v_mov_b32 v77, 0
    v_mov_b32 v78, 0
    v_mov_b32 v79, 0
    v_mov_b32 v80, 0
    v_mov_b32 v81, 0
    v_mov_b32 v82, 0
    v_mov_b32 v83, 0
    v_mov_b32 v84, 0
    v_mov_b32 v85, 0
    v_mov_b32 v86, 0
    v_mov_b32 v87, 0
    v_mov_b32 v88, 0
    v_mov_b32 v89, 0
    v_mov_b32 v90, 0
    v_mov_b32 v91, 0
    s_mov_b32 s28, 0
    s_barrier
    v_add_u32 v10, s28, v6
    v_add_u32 v11, s28, v7
    v_add_u32 v12, s28, v8
    v_add_u32 v13, s28, v9
    s_add_u32 s28, s28, 20480
    s_cmp_ge_u32 s28, 81920
    s_cselect_b32 s49, 81920, 0
    s_sub_u32 s28, s28, s49
    ds_read_b128 v[28:31], v10 offset:0
    ds_read_b128 v[32:35], v10 offset:2048
    ds_read_b128 v[36:39], v10 offset:4096
    ds_read_b128 v[52:55], v12 offset:0
    ds_read_b128 v[56:59], v12 offset:2048
    s_sub_u32 s24, s24, 1
gb_loop:
    s_waitcnt lgkmcnt(0)
    v_mfma_f32_16x16x32_bf16 v[68:71], v[52:55], v[28:31], v[68:71]
    ds_read_b128 v[40:43], v11 offset:0
    ds_read_b128 v[44:47], v11 offset:2048
    v_mfma_f32_16x16x32_bf16 v[76:79], v[52:55], v[32:35], v[76:79]
    ds_read_b128 v[48:51], v11 offset:4096
    ds_read_b128 v[60:63], v13 offset:0
    v_mfma_f32_16x16x32_bf16 v[84:87], v[52:55], v[36:39], v[84:87]
    ds_read_b128 v[64:67], v13 offset:2048
    v_mfma_f32_16x16x32_bf16 v[72:75], v[56:59], v[28:31], v[72:75]
    v_mfma_f32_16x16x32_bf16 v[80:83], v[56:59], v[32:35], v[80:83]
    v_mfma_f32_16x16x32_bf16 v[88:91], v[56:59], v[36:39], v[88:91]
    s_waitcnt lgkmcnt(0)
    s_barrier
    v_add_u32 v10, s28, v6
    v_add_u32 v11, s28, v7
    v_add_u32 v12, s28, v8
    v_add_u32 v13, s28, v9
    v_mfma_f32_16x16x32_bf16 v[68:71], v[60:63], v[40:43], v[68:71]
    ds_read_b128 v[28:31], v10 offset:0
    ds_read_b128 v[32:35], v10 offset:2048
    v_mfma_f32_16x16x32_bf16 v[76:79], v[60:63], v[44:47], v[76:79]
    ds_read_b128 v[36:39], v10 offset:4096
    ds_read_b128 v[52:55], v12 offset:0
    v_mfma_f32_16x16x32_bf16 v[84:87], v[60:63], v[48:51], v[84:87]
    ds_read_b128 v[56:59], v12 offset:2048
    s_add_u32 s28, s28, 20480
    v_mfma_f32_16x16x32_bf16 v[72:75], v[64:67], v[40:43], v[72:75]
    s_cmp_ge_u32 s28, 81920
    s_cselect_b32 s49, 81920, 0
    v_mfma_f32_16x16x32_bf16 v[80:83], v[64:67], v[44:47], v[80:83]
    s_sub_u32 s28, s28, s49
    v_mfma_f32_16x16x32_bf16 v[88:91], v[64:67], v[48:51], v[88:91]
    s_sub_u32 s24, s24, 1
    s_cmp_lg_u32 s24, 0
    s_cbranch_scc1 gb_loop
    s_waitcnt lgkmcnt(0)
    v_mfma_f32_16x16x32_bf16 v[68:71], v[52:55], v[28:31], v[68:71]
    ds_read_b128 v[40:43], v11 offset:0
    ds_read_b128 v[44:47], v11 offset:2048
    v_mfma_f32_16x16x32_bf16 v[76:79], v[52:55], v[32:35], v[76:79]
    ds_read_b128 v[48:51], v11 offset:4096
    ds_read_b128 v[60:63], v13 offset:0
    v_mfma_f32_16x16x32_bf16 v[84:87], v[52:55], v[36:39], v[84:87]
    ds_read_b128 v[64:67], v13 offset:2048
    v_mfma_f32_16x16x32_bf16 v[72:75], v[56:59], v[28:31], v[72:75]
    v_mfma_f32_16x16x32_bf16 v[80:83], v[56:59], v[32:35], v[80:83]
    v_mfma_f32_16x16x32_bf16 v[88:91], v[56:59], v[36:39], v[88:91]
    s_waitcnt lgkmcnt(0)
    v_mfma_f32_16x16x32_bf16 v[68:71], v[60:63], v[40:43], v[68:71]
    v_mfma_f32_16x16x32_bf16 v[76:79], v[60:63], v[44:47], v[76:79]
    v_mfma_f32_16x16x32_bf16 v[84:87], v[60:63], v[48:51], v[84:87]
    v_mfma_f32_16x16x32_bf16 v[72:75], v[64:67], v[40:43], v[72:75]
    v_mfma_f32_16x16x32_bf16 v[80:83], v[64:67], v[44:47], v[80:83]
    v_mfma_f32_16x16x32_bf16 v[88:91], v[64:67], v[48:51], v[88:91]
    s_nop 7
    s_nop 1
    s_lshl_b32 s45, s33, 4
    s_mov_b32 s46, 0
    buffer_store_dwordx4 v[68:71], v22, s[16:19], s46 offen offset:0
    buffer_store_dwordx4 v[72:75], v22, s[16:19], s46 offen offset:64
    s_add_u32 s46, s46, s45
    buffer_store_dwordx4 v[76:79], v22, s[16:19], s46 offen offset:0
    buffer_store_dwordx4 v[80:83], v22, s[16:19], s46 offen offset:64
    s_add_u32 s46, s46, s45
    buffer_store_dwordx4 v[84:87], v22, s[16:19], s46 offen offset:0
    buffer_store_dwordx4 v[88:91], v22, s[16:19], s46 offen offset:64
    s_add_u32 s46, s46, s45
gb_end:
    s_endpgm
gb_stream:
    s_sub_u32 s2, s2, 200
    v_lshrrev_b32 v1, 6, v0
    v_and_b32 v0, 63, v0
    v_readfirstlane_b32 s3, v1
    v_lshlrev_b32 v0, 4, v0
    s_cmp_ge_u32 s2, 112
    s_cbranch_scc1 gb_st1
    s_load_dwordx2 s[4:5], s[0:1], 56
    s_mul_i32 s6, s2, 8
    s_add_u32 s6, s6, s3
    s_mul_i32 s6, s6, 8192
    s_waitcnt lgkmcnt(0)
    s_add_u32 s8, s4, s6
    s_addc_u32 s9, s5, 0
    s_sub_u32 s10, 7340032, s6
    s_cselect_b32 s10, 0, s10
    s_mov_b32 s11, 0x00020000
    s_mov_b32 s7, 0
    buffer_load_dwordx4 v[4:7], v0, s[8:11], s7 offen offset:0
    s_add_u32 s7, s7, 1024
    buffer_load_dwordx4 v[4:7], v0, s[8:11], s7 offen offset:0
    s_add_u32 s7, s7, 1024
    buffer_load_dwordx4 v[4:7], v0, s[8:11], s7 offen offset:0
    s_add_u32 s7, s7, 1024
    buffer_load_dwordx4 v[4:7], v0, s[8:11], s7 offen offset:0
    s_add_u32 s7, s7, 1024
    buffer_load_dwordx4 v[4:7], v0, s[8:11], s7 offen offset:0
    s_add_u32 s7, s7, 1024
    buffer_load_dwordx4 v[4:7], v0, s[8:11], s7 offen offset:0
    s_add_u32 s7, s7, 1024
    buffer_load_dwordx4 v[4:7], v0, s[8:11], s7 offen offset:0
    s_add_u32 s7, s7, 1024
    buffer_load_dwordx4 v[4:7], v0, s[8:11], s7 offen offset:0
    s_waitcnt vmcnt(0)
    s_endpgm
gb_st1:
    s_sub_u32 s2, s2, 112
    s_branch gb_end
.globl ln2_kernel
.p2align 8
.type ln2_kernel,@function
ln2_kernel:
    s_cmp_ge_u32 s2, 512
    s_cbranch_scc1 ln2_end
    s_load_dwordx2 s[4:5], s[0:1], 0
    s_load_dwordx2 s[6:7], s[0:1], 80
    v_lshrrev_b32 v1, 6, v0
    v_and_b32 v0, 63, v0
    v_readfirstlane_b32 s3, v1
    s_lshl_b32 s20, s2, 2
    s_add_u32 s20, s20, s3
    s_sub_u32 s21, 2048, s20
    s_cmp_le_u32 s20, 1024
    s_cselect_b32 s22, s20, s21
    s_cselect_b32 s23, 1.0, -1.0
    s_waitcnt lgkmcnt(0)
    s_lshl_b32 s24, s20, 11
    s_add_u32 s8, s4, s24
    s_addc_u32 s9, s5, 0
    s_mov_b32 s10, 2048
    s_mov_b32 s11, 0x00020000
    s_mul_i32 s25, s22, 2304
    s_add_u32 s25, s25, 8388608
    s_add_u32 s12, s6, s25
    s_addc_u32 s13, s7, 0
    s_mov_b32 s14, 2304
    s_mov_b32 s15, 0x00020000
    s_lshl_b32 s25, s22, 11
    s_add_u32 s25, s25, 12582912
    s_add_u32 s16, s6, s25
    s_addc_u32 s17, s7, 0
    s_mov_b32 s18, 2048
    s_mov_b32 s19, 0x00020000
    s_add_u32 s25, s24, 20971520
    s_add_u32 s28, s6, s25
    s_addc_u32 s29, s7, 0
    s_mov_b32 s30, 2048
    s_mov_b32 s31, 0x00020000
    s_add_u32 s25, s24, 16777216
    s_add_u32 s32, s6, s25
    s_addc_u32 s33, s7, 0
    s_mov_b32 s34, 2048
    s_mov_b32 s35, 0x00020000
    v_lshlrev_b32 v1, 4, v0
    v_lshlrev_b32 v2, 5, v0
    v_sub_u32 v3, 2020, v2
    buffer_load_dwordx4 v[4:7], v1, s[8:11], 0 offen
    buffer_load_dwordx4 v[8:11], v1, s[8:11], 0 offen offset:1024
    buffer_load_dwordx4 v[12:15], v2, s[12:15], 0 offen
    buffer_load_dwordx4 v[16:19], v2, s[12:15], 0 offen offset:16
    buffer_load_dwordx4 v[20:23], v2, s[16:19], 0 offen
    buffer_load_dwordx4 v[24:27], v2, s[16:19], 0 offen offset:16
    buffer_load_dwordx4 v[28:31], v3, s[12:15], 0 offen
    buffer_load_dwordx4 v[32:35], v3, s[12:15], 0 offen offset:16
    buffer_load_dwordx4 v[36:39], v3, s[16:19], 0 offen
    buffer_load_dwordx3 v[40:42], v3, s[16:19], 0 offen offset:16
    buffer_load_dword v43, v3, s[16:19], 0 offen offset:28
    s_waitcnt vmcnt(0)
    v_and_b32 v45, 0xffff0000, v4
    v_lshlrev_b32 v44, 16, v4
    v_and_b32 v47, 0xffff0000, v5
    v_lshlrev_b32 v46, 16, v5
    v_and_b32 v49, 0xffff0000, v6
    v_lshlrev_b32 v48, 16, v6
    v_and_b32 v51, 0xffff0000, v7
    v_lshlrev_b32 v50, 16, v7
    v_and_b32 v53, 0xffff0000, v8
    v_lshlrev_b32 v52, 16, v8
    v_and_b32 v55, 0xffff0000, v9
    v_lshlrev_b32 v54, 16, v9
    v_and_b32 v57, 0xffff0000, v10
    v_lshlrev_b32 v56, 16, v10
    v_and_b32 v59, 0xffff0000, v11
    v_lshlrev_b32 v58, 16, v11
    v_fma_f32 v12, -v20, s23, v12
    v_fma_f32 v28, v36, s23, v28
    v_fma_f32 v13, -v21, s23, v13
    v_fma_f32 v29, v37, s23, v29
    v_fma_f32 v14, -v22, s23, v14
    v_fma_f32 v30, v38, s23, v30
    v_fma_f32 v15, -v23, s23, v15
    v_fma_f32 v31, v39, s23, v31
    v_fma_f32 v16, -v24, s23, v16
    v_fma_f32 v32, v40, s23, v32
    v_fma_f32 v17, -v25, s23, v17
    v_fma_f32 v33, v41, s23, v33
    v_fma_f32 v18, -v26, s23, v18
    v_fma_f32 v34, v42, s23, v34
    v_fma_f32 v19, -v27, s23, v19
    v_fma_f32 v35, v43, s23, v35
    v_add_f32 v60, v44, v12
    v_add_f32 v68, v52, v35
    v_add_f32 v61, v45, v13
    v_add_f32 v69, v53, v34
    v_add_f32 v62, v46, v14
    v_add_f32 v70, v54, v33
    v_add_f32 v63, v47, v15
    v_add_f32 v71, v55, v32
    v_add_f32 v64, v48, v16
    v_add_f32 v72, v56, v31
    v_add_f32 v65, v49, v17
    v_add_f32 v73, v57, v30
    v_add_f32 v66, v50, v18
    v_add_f32 v74, v58, v29
    v_add_f32 v67, v51, v19
    v_add_f32 v75, v59, v28
    v_cvt_pk_bf16_f32 v76, v60, v61
    v_cvt_pk_bf16_f32 v77, v62, v63
    v_cvt_pk_bf16_f32 v78, v64, v65
    v_cvt_pk_bf16_f32 v79, v66, v67
    v_cvt_pk_bf16_f32 v80, v68, v69
    v_cvt_pk_bf16_f32 v81, v70, v71
    v_cvt_pk_bf16_f32 v82, v72, v73
    v_cvt_pk_bf16_f32 v83, v74, v75
    buffer_store_dwordx4 v[76:79], v1, s[28:31], 0 offen
    buffer_store_dwordx4 v[80:83], v1, s[28:31], 0 offen offset:1024
    v_and_b32 v61, 0xffff0000, v76
    v_lshlrev_b32 v60, 16, v76
    v_and_b32 v63, 0xffff0000, v77
    v_lshlrev_b32 v62, 16, v77
    v_and_b32 v65, 0xffff0000, v78
    v_lshlrev_b32 v64, 16, v78
    v_and_b32 v67, 0xffff0000, v79
    v_lshlrev_b32 v66, 16, v79
    v_and_b32 v69, 0xffff0000, v80
    v_lshlrev_b32 v68, 16, v80
    v_and_b32 v71, 0xffff0000, v81
    v_lshlrev_b32 v70, 16, v81
    v_and_b32 v73, 0xffff0000, v82
    v_lshlrev_b32 v72, 16, v82
    v_and_b32 v75, 0xffff0000, v83
    v_lshlrev_b32 v74, 16, v83
    v_add_f32 v84, v60, v61
    v_add_f32 v84, v84, v62
    v_add_f32 v84, v84, v63
    v_add_f32 v84, v84, v64
    v_add_f32 v84, v84, v65
    v_add_f32 v84, v84, v66
    v_add_f32 v84, v84, v67
    v_add_f32 v84, v84, v68
    v_add_f32 v84, v84, v69
    v_add_f32 v84, v84, v70
    v_add_f32 v84, v84, v71
    v_add_f32 v84, v84, v72
    v_add_f32 v84, v84, v73
    v_add_f32 v84, v84, v74
    v_add_f32 v84, v84, v75
    s_nop 1
    v_add_f32_dpp v84, v84, v84 row_shr:1 row_mask:0xf bank_mask:0xf bound_ctrl:0
    s_nop 1
    v_add_f32_dpp v84, v84, v84 row_shr:2 row_mask:0xf bank_mask:0xf bound_ctrl:0
    s_nop 1
    v_add_f32_dpp v84, v84, v84 row_shr:4 row_mask:0xf bank_mask:0xf bound_ctrl:0
    s_nop 1
    v_add_f32_dpp v84, v84, v84 row_shr:8 row_mask:0xf bank_mask:0xf bound_ctrl:0
    s_nop 1
    v_add_f32_dpp v84, v84, v84 row_bcast:15 row_mask:0xa bank_mask:0xf
    s_nop 1
    v_add_f32_dpp v84, v84, v84 row_bcast:31 row_mask:0xc bank_mask:0xf
    s_nop 1
    v_readlane_b32 s26, v84, 63
    s_nop 1
    v_mov_b32 v84, s26
    v_mul_f32 v84, 0x3a800000, v84
    v_sub_f32 v60, v60, v84
    v_sub_f32 v61, v61, v84
    v_sub_f32 v62, v62, v84
    v_sub_f32 v63, v63, v84
    v_sub_f32 v64, v64, v84
    v_sub_f32 v65, v65, v84
    v_sub_f32 v66, v66, v84
    v_sub_f32 v67, v67, v84
    v_sub_f32 v68, v68, v84
    v_sub_f32 v69, v69, v84
    v_sub_f32 v70, v70, v84
    v_sub_f32 v71, v71, v84
    v_sub_f32 v72, v72, v84
    v_sub_f32 v73, v73, v84
    v_sub_f32 v74, v74, v84
    v_sub_f32 v75, v75, v84
    v_mul_f32 v84, v60, v60
    v_fmac_f32 v84, v61, v61
    v_fmac_f32 v84, v62, v62
    v_fmac_f32 v84, v63, v63
    v_fmac_f32 v84, v64, v64
    v_fmac_f32 v84, v65, v65
    v_fmac_f32 v84, v66, v66
    v_fmac_f32 v84, v67, v67
    v_fmac_f32 v84, v68, v68
    v_fmac_f32 v84, v69, v69
    v_fmac_f32 v84, v70, v70
    v_fmac_f32 v84, v71, v71
    v_fmac_f32 v84, v72, v72
    v_fmac_f32 v84, v73, v73
    v_fmac_f32 v84, v74, v74
    v_fmac_f32 v84, v75, v75
    s_nop 1
    v_add_f32_dpp v84, v84, v84 row_shr:1 row_mask:0xf bank_mask:0xf bound_ctrl:0
    s_nop 1
    v_add_f32_dpp v84, v84, v84 row_shr:2 row_mask:0xf bank_mask:0xf bound_ctrl:0
    s_nop 1
    v_add_f32_dpp v84, v84, v84 row_shr:4 row_mask:0xf bank_mask:0xf bound_ctrl:0
    s_nop 1
    v_add_f32_dpp v84, v84, v84 row_shr:8 row_mask:0xf bank_mask:0xf bound_ctrl:0
    s_nop 1
    v_add_f32_dpp v84, v84, v84 row_bcast:15 row_mask:0xa bank_mask:0xf
    s_nop 1
    v_add_f32_dpp v84, v84, v84 row_bcast:31 row_mask:0xc bank_mask:0xf
    s_nop 1
    v_readlane_b32 s27, v84, 63
    s_nop 1
    v_mov_b32 v84, s27
    v_mul_f32 v84, 0x3a800000, v84
    v_add_f32 v84, 0x3727c5ac, v84
    v_rsq_f32 v84, v84
    s_nop 0
    v_mul_f32 v60, v60, v84
    v_mul_f32 v61, v61, v84
    v_mul_f32 v62, v62, v84
    v_mul_f32 v63, v63, v84
    v_mul_f32 v64, v64, v84
    v_mul_f32 v65, v65, v84
    v_mul_f32 v66, v66, v84
    v_mul_f32 v67, v67, v84
    v_mul_f32 v68, v68, v84
    v_mul_f32 v69, v69, v84
    v_mul_f32 v70, v70, v84
    v_mul_f32 v71, v71, v84
    v_mul_f32 v72, v72, v84
    v_mul_f32 v73, v73, v84
    v_mul_f32 v74, v74, v84
    v_mul_f32 v75, v75, v84
    v_cvt_pk_bf16_f32 v88, v60, v61
    v_cvt_pk_bf16_f32 v89, v62, v63
    v_cvt_pk_bf16_f32 v90, v64, v65
    v_cvt_pk_bf16_f32 v91, v66, v67
    v_cvt_pk_bf16_f32 v92, v68, v69
    v_cvt_pk_bf16_f32 v93, v70, v71
    v_cvt_pk_bf16_f32 v94, v72, v73
    v_cvt_pk_bf16_f32 v95, v74, v75
    buffer_store_dwordx4 v[88:91], v1, s[32:35], 0 offen
    buffer_store_dwordx4 v[92:95], v1, s[32:35], 0 offen offset:1024
ln2_end:
    s_endpgm
.globl g1_kernel
.p2align 8
.type g1_kernel,@function
g1_kernel:
    s_cmp_ge_u32 s2, 256
    s_cbranch_scc1 g1_end
    s_load_dwordx2 s[40:41], s[0:1], 80
    s_and_b32 s50, s2, 7
    s_lshr_b32 s51, s2, 3
    s_and_b32 s52, s50, 1
    s_lshl_b32 s52, s52, 3
    s_and_b32 s53, s51, 7
    s_add_u32 s54, s52, s53
    s_lshr_b32 s52, s50, 1
    s_lshl_b32 s52, s52, 2
    s_lshr_b32 s53, s51, 3
    s_add_u32 s55, s52, s53
    s_load_dwordx2 s[6:7], s[0:1], 48
    s_mov_b32 s31, 2048
    s_mov_b32 s32, 7168
    s_mov_b32 s33, 7168
    s_mov_b32 s24, 16
    s_waitcnt lgkmcnt(0)
    s_mul_i32 s52, s54, 262144
    s_sub_u32 s42, 4194304, s52
    s_add_u32 s52, s52, 16777216
    s_add_u32 s4, s40, s52
    s_addc_u32 s5, s41, 0
    s_mul_i32 s52, s55, 448
    s_sub_u32 s43, 7340032, s52
    s_add_u32 s6, s6, s52
    s_addc_u32 s7, s7, 0
    s_mul_i32 s52, s54, 917504
    s_mul_i32 s53, s55, 448
    s_add_u32 s52, s52, s53
    s_sub_u32 s44, 14680064, s52
    s_add_u32 s52, s52, 25165824
    s_add_u32 s36, s40, s52
    s_addc_u32 s37, s41, 0
    s_mov_b32 s8, s4
    s_mov_b32 s9, s5
    s_mov_b32 s10, s42
    s_mov_b32 s11, 0x00020000
    s_mov_b32 s12, s6
    s_mov_b32 s13, s7
    s_mov_b32 s14, s43
    s_mov_b32 s15, 0x00020000
    s_mov_b32 s16, s36
    s_mov_b32 s17, s37
    s_mov_b32 s18, s44
    s_mov_b32 s19, 0x00020000
    v_lshrrev_b32 v20, 6, v0
    v_and_b32 v0, 63, v0
    v_readfirstlane_b32 s29, v20
    s_nop 3
    s_cmp_lt_u32 s29, 4
    s_cbranch_scc1 g1_compute
    s_sub_u32 s29, s29, 4
    v_subrev_u32 v20, 4, v20
    s_setprio 2
    v_lshrrev_b32 v21, 3, v0
    v_lshl_add_u32 v21, v20, 3, v21
    v_bfe_u32 v22, v21, 1, 3
    v_and_b32 v23, 7, v0
    v_xor_b32 v22, v22, v23
    v_lshlrev_b32 v22, 4, v22
    v_mul_lo_u32 v23, v21, s31
    v_add_u32 v1, v23, v22
    s_lshl_b32 s45, s31, 5
    v_add_u32 v2, s45, v1
    v_add_u32 v3, s45, v2
    v_add_u32 v4, s45, v3
    v_lshl_add_u32 v21, v20, 6, v0
    v_mul_u32_u24 v22, 2341, v21
    v_lshrrev_b32 v22, 16, v22
    v_mul_u32_u24 v23, 28, v22
    v_sub_u32 v23, v21, v23
    v_bfe_u32 v24, v22, 3, 1
    v_lshlrev_b32 v24, 1, v24
    v_xor_b32 v23, v23, v24
    v_mul_lo_u32 v22, v22, s32
    v_lshl_add_u32 v5, v23, 4, v22
    v_lshl_add_u32 v21, v20, 6, v0
    v_add_u32 v21, 256, v21
    v_mul_u32_u24 v22, 2341, v21
    v_lshrrev_b32 v22, 16, v22
    v_mul_u32_u24 v23, 28, v22
    v_sub_u32 v23, v21, v23
    v_bfe_u32 v24, v22, 3, 1
    v_lshlrev_b32 v24, 1, v24
    v_xor_b32 v23, v23, v24
    v_mul_lo_u32 v22, v22, s32
    v_lshl_add_u32 v6, v23, 4, v22
    v_lshl_add_u32 v21, v20, 6, v0
    v_add_u32 v21, 512, v21
    v_mul_u32_u24 v22, 2341, v21
    v_lshrrev_b32 v22, 16, v22
    v_mul_u32_u24 v23, 28, v22
    v_sub_u32 v23, v21, v23
    v_bfe_u32 v24, v22, 3, 1
    v_lshlrev_b32 v24, 1, v24
    v_xor_b32 v23, v23, v24
    v_mul_lo_u32 v22, v22, s32
    v_lshl_add_u32 v7, v23, 4, v22
    v_lshl_add_u32 v21, v20, 6, v0
    v_add_u32 v21, 768, v21
    v_mul_u32_u24 v22, 2341, v21
    v_lshrrev_b32 v22, 16, v22
    v_mul_u32_u24 v23, 28, v22
    v_sub_u32 v23, v21, v23
    v_bfe_u32 v24, v22, 3, 1
    v_lshlrev_b32 v24, 1, v24
    v_xor_b32 v23, v23, v24
    v_mul_lo_u32 v22, v22, s32
    v_lshl_add_u32 v8, v23, 4, v22
    v_lshl_add_u32 v21, v20, 6, v0
    v_add_u32 v21, 1024, v21
    v_mul_u32_u24 v22, 2341, v21
    v_lshrrev_b32 v22, 16, v22
    v_mul_u32_u24 v23, 28, v22
    v_sub_u32 v23, v21, v23
    v_bfe_u32 v24, v22, 3, 1
    v_lshlrev_b32 v24, 1, v24
    v_xor_b32 v23, v23, v24
    v_mul_lo_u32 v22, v22, s32
    v_lshl_add_u32 v9, v23, 4, v22
    v_lshl_add_u32 v21, v20, 6, v0
    v_add_u32 v21, 1280, v21
    v_mul_u32_u24 v22, 2341, v21
    v_lshrrev_b32 v22, 16, v22
    v_mul_u32_u24 v23, 28, v22
    v_sub_u32 v23, v21, v23
    v_bfe_u32 v24, v22, 3, 1
    v_lshlrev_b32 v24, 1, v24
    v_xor_b32 v23, v23, v24
    v_mul_lo_u32 v22, v22, s32
    v_lshl_add_u32 v10, v23, 4, v22
    v_lshl_add_u32 v21, v20, 6, v0
    v_add_u32 v21, 1536, v21
    v_mul_u32_u24 v22, 2341, v21
    v_lshrrev_b32 v22, 16, v22
    v_mul_u32_u24 v23, 28, v22
    v_sub_u32 v23, v21, v23
    v_bfe_u32 v24, v22, 3, 1
    v_lshlrev_b32 v24, 1, v24
    v_xor_b32 v23, v23, v24
    v_mul_lo_u32 v22, v22, s32
    v_lshl_add_u32 v11, v23, 4, v22
    s_lshl_b32 s34, s32, 6
    s_mov_b32 s25, 0
    s_mov_b32 s26, 0
    s_lshl_b32 s27, s29, 10
    s_add_u32 s48, s27, 135168
    s_mov_b32 m0, s27
    s_nop 0
    buffer_load_dwordx4 v1, s[8:11], s25 offen lds
    s_add_u32 m0, m0, 0x1000
    s_nop 0
    buffer_load_dwordx4 v2, s[8:11], s25 offen lds
    s_add_u32 m0, m0, 0x1000
    s_nop 0
    buffer_load_dwordx4 v3, s[8:11], s25 offen lds
    s_add_u32 m0, m0, 0x1000
    s_nop 0
    buffer_load_dwordx4 v4, s[8:11], s25 offen lds
    s_add_u32 m0, m0, 0x1000
    s_nop 0
    buffer_load_dwordx4 v5, s[12:15], s26 offen lds
    s_add_u32 m0, m0, 0x1000
    s_nop 0
    buffer_load_dwordx4 v6, s[12:15], s26 offen lds
    s_add_u32 m0, m0, 0x1000
    s_nop 0
    buffer_load_dwordx4 v7, s[12:15], s26 offen lds
    s_add_u32 m0, m0, 0x1000
    s_nop 0
    buffer_load_dwordx4 v8, s[12:15], s26 offen lds
    s_add_u32 m0, m0, 0x1000
    s_nop 0
    buffer_load_dwordx4 v9, s[12:15], s26 offen lds
    s_add_u32 m0, m0, 0x1000
    s_nop 0
    buffer_load_dwordx4 v10, s[12:15], s26 offen lds
    s_add_u32 m0, m0, 0x1000
    s_nop 0
    buffer_load_dwordx4 v11, s[12:15], s26 offen lds
    s_add_u32 s25, s25, 128
    s_add_u32 s26, s26, s34
    s_add_u32 s27, s27, 45056
    s_cmp_ge_u32 s27, s48
    s_cselect_b32 s49, 135168, 0
    s_sub_u32 s27, s27, s49
    s_mov_b32 m0, s27
    s_nop 0
    buffer_load_dwordx4 v1, s[8:11], s25 offen lds
    s_add_u32 m0, m0, 0x1000
    s_nop 0
    buffer_load_dwordx4 v2, s[8:11], s25 offen lds
    s_add_u32 m0, m0, 0x1000
    s_nop 0
    buffer_load_dwordx4 v3, s[8:11], s25 offen lds
    s_add_u32 m0, m0, 0x1000
    s_nop 0
    buffer_load_dwordx4 v4, s[8:11], s25 offen lds
    s_add_u32 m0, m0, 0x1000
    s_nop 0
    buffer_load_dwordx4 v5, s[12:15], s26 offen lds
    s_add_u32 m0, m0, 0x1000
    s_nop 0
    buffer_load_dwordx4 v6, s[12:15], s26 offen lds
    s_add_u32 m0, m0, 0x1000
    s_nop 0
    buffer_load_dwordx4 v7, s[12:15], s26 offen lds
    s_add_u32 m0, m0, 0x1000
    s_nop 0
    buffer_load_dwordx4 v8, s[12:15], s26 offen lds
    s_add_u32 m0, m0, 0x1000
    s_nop 0
    buffer_load_dwordx4 v9, s[12:15], s26 offen lds
    s_add_u32 m0, m0, 0x1000
    s_nop 0
    buffer_load_dwordx4 v10, s[12:15], s26 offen lds
    s_add_u32 m0, m0, 0x1000
    s_nop 0
    buffer_load_dwordx4 v11, s[12:15], s26 offen lds
    s_add_u32 s25, s25, 128
    s_add_u32 s26, s26, s34
    s_add_u32 s27, s27, 45056
    s_cmp_ge_u32 s27, s48
    s_cselect_b32 s49, 135168, 0
    s_sub_u32 s27, s27, s49
    s_mov_b32 m0, s27
    s_nop 0
    buffer_load_dwordx4 v1, s[8:11], s25 offen lds
    s_add_u32 m0, m0, 0x1000
    s_nop 0
    buffer_load_dwordx4 v2, s[8:11], s25 offen lds
    s_add_u32 m0, m0, 0x1000
    s_nop 0
    buffer_load_dwordx4 v3, s[8:11], s25 offen lds
    s_add_u32 m0, m0, 0x1000
    s_nop 0
    buffer_load_dwordx4 v4, s[8:11], s25 offen lds
    s_add_u32 m0, m0, 0x1000
    s_nop 0
    buffer_load_dwordx4 v5, s[12:15], s26 offen lds
    s_add_u32 m0, m0, 0x1000
    s_nop 0
    buffer_load_dwordx4 v6, s[12:15], s26 offen lds
    s_add_u32 m0, m0, 0x1000
    s_nop 0
    buffer_load_dwordx4 v7, s[12:15], s26 offen lds
    s_add_u32 m0, m0, 0x1000
    s_nop 0
    buffer_load_dwordx4 v8, s[12:15], s26 offen lds
    s_add_u32 m0, m0, 0x1000
    s_nop 0
    buffer_load_dwordx4 v9, s[12:15], s26 offen lds
    s_add_u32 m0, m0, 0x1000
    s_nop 0
    buffer_load_dwordx4 v10, s[12:15], s26 offen lds
    s_add_u32 m0, m0, 0x1000
    s_nop 0
    buffer_load_dwordx4 v11, s[12:15], s26 offen lds
    s_add_u32 s25, s25, 128
    s_add_u32 s26, s26, s34
    s_add_u32 s27, s27, 45056
    s_cmp_ge_u32 s27, s48
    s_cselect_b32 s49, 135168, 0
    s_sub_u32 s27, s27, s49
    s_waitcnt vmcnt(22)
    s_barrier
    s_sub_u32 s24, s24, 3
    s_cmp_eq_u32 s24, 0
    s_cbranch_scc1 g1_ltail
g1_lloop:
    s_waitcnt vmcnt(11)
    s_barrier
    s_mov_b32 m0, s27
    s_nop 0
    buffer_load_dwordx4 v1, s[8:11], s25 offen lds
    s_add_u32 m0, m0, 0x1000
    s_nop 0
    buffer_load_dwordx4 v2, s[8:11], s25 offen lds
    s_add_u32 m0, m0, 0x1000
    s_nop 0
    buffer_load_dwordx4 v3, s[8:11], s25 offen lds
    s_add_u32 m0, m0, 0x1000
    s_nop 0
    buffer_load_dwordx4 v4, s[8:11], s25 offen lds
    s_add_u32 m0, m0, 0x1000
    s_nop 0
    buffer_load_dwordx4 v5, s[12:15], s26 offen lds
    s_add_u32 m0, m0, 0x1000
    s_nop 0
    buffer_load_dwordx4 v6, s[12:15], s26 offen lds
    s_add_u32 m0, m0, 0x1000
    s_nop 0
    buffer_load_dwordx4 v7, s[12:15], s26 offen lds
    s_add_u32 m0, m0, 0x1000
    s_nop 0
    buffer_load_dwordx4 v8, s[12:15], s26 offen lds
    s_add_u32 m0, m0, 0x1000
    s_nop 0
    buffer_load_dwordx4 v9, s[12:15], s26 offen lds
    s_add_u32 m0, m0, 0x1000
    s_nop 0
    buffer_load_dwordx4 v10, s[12:15], s26 offen lds
    s_add_u32 m0, m0, 0x1000
    s_nop 0
    buffer_load_dwordx4 v11, s[12:15], s26 offen lds
    s_add_u32 s25, s25, 128
    s_add_u32 s26, s26, s34
    s_add_u32 s27, s27, 45056
    s_cmp_ge_u32 s27, s48
    s_cselect_b32 s49, 135168, 0
    s_sub_u32 s27, s27, s49
    s_sub_u32 s24, s24, 1
    s_cmp_lg_u32 s24, 0
    s_cbranch_scc1 g1_lloop
g1_ltail:
    s_waitcnt vmcnt(11)
    s_barrier
    s_waitcnt vmcnt(0)
    s_barrier
    s_endpgm
g1_compute:
    s_lshl_b32 s84, s32, 6
    s_lshr_b32 s46, s29, 1
    s_and_b32 s47, s29, 1
    v_and_b32 v21, 15, v0
    v_lshrrev_b32 v22, 4, v0
    v_lshrrev_b32 v23, 1, v21
    v_xor_b32 v23, v23, v22
    v_lshlrev_b32 v23, 4, v23
    v_lshl_add_u32 v23, v21, 7, v23
    s_mul_i32 s45, s46, 8192
    v_add_u32 v12, s45, v23
    v_xor_b32 v13, 64, v12
    v_lshrrev_b32 v23, 2, v21
    v_lshl_add_u32 v24, v22, 3, v23
    v_and_b32 v23, 1, v22
    v_lshlrev_b32 v23, 1, v23
    v_mul_u32_u24 v24, 28, v24
    v_bfe_u32 v25, v0, 1, 1
    s_mul_i32 s45, s47, 14
    s_add_u32 s45, s45, 0
    v_add_u32 v14, s45, v25
    v_xor_b32 v14, v14, v23
    v_add_u32 v14, v14, v24
    v_lshlrev_b32 v14, 4, v14
    v_and_b32 v26, 1, v0
    v_lshl_add_u32 v14, v26, 3, v14
    v_add_u32 v14, 16384, v14
    s_mul_i32 s45, s47, 14
    s_add_u32 s45, s45, 2
    v_add_u32 v15, s45, v25
    v_xor_b32 v15, v15, v23
    v_add_u32 v15, v15, v24
    v_lshlrev_b32 v15, 4, v15
    v_and_b32 v26, 1, v0
    v_lshl_add_u32 v15, v26, 3, v15
    v_add_u32 v15, 16384, v15
    s_mul_i32 s45, s46, 64
    v_add_u32 v21, s45, v21
    v_mul_lo_u32 v28, v21, s33
    s_mul_i32 s45, s47, 224
    v_lshlrev_b32 v22, 3, v22
    v_add3_u32 v28, v28, v22, s45
    v_sub_u32 v30, v28, v22
    v_bfe_u32 v23, v0, 4, 1
    v_lshl_add_u32 v30, v23, 5, v30
    v_lshrrev_b32 v23, 5, v0
    v_lshl_add_u32 v30, v23, 4, v30
    v_mov_b32 v120, 0
    v_mov_b32 v121, 0
    v_mov_b32 v122, 0
    v_mov_b32 v123, 0
    v_mov_b32 v124, 0
    v_mov_b32 v125, 0
    v_mov_b32 v126, 0
    v_mov_b32 v127, 0
    v_mov_b32 v128, 0
    v_mov_b32 v129, 0
    v_mov_b32 v130, 0
    v_mov_b32 v131, 0
    v_mov_b32 v132, 0
    v_mov_b32 v133, 0
    v_mov_b32 v134, 0
    v_mov_b32 v135, 0
    v_mov_b32 v136, 0
    v_mov_b32 v137, 0
    v_mov_b32 v138, 0
    v_mov_b32 v139, 0
    v_mov_b32 v140, 0
    v_mov_b32 v141, 0
    v_mov_b32 v142, 0
    v_mov_b32 v143, 0
    v_mov_b32 v144, 0
    v_mov_b32 v145, 0
    v_mov_b32 v146, 0
    v_mov_b32 v147, 0
    v_mov_b32 v148, 0
    v_mov_b32 v149, 0
    v_mov_b32 v150, 0
    v_mov_b32 v151, 0
    v_mov_b32 v152, 0
    v_mov_b32 v153, 0
    v_mov_b32 v154, 0
    v_mov_b32 v155, 0
    v_mov_b32 v156, 0
    v_mov_b32 v157, 0
    v_mov_b32 v158, 0
    v_mov_b32 v159, 0
    v_mov_b32 v160, 0
    v_mov_b32 v161, 0
    v_mov_b32 v162, 0
    v_mov_b32 v163, 0
    v_mov_b32 v164, 0
    v_mov_b32 v165, 0
    v_mov_b32 v166, 0
    v_mov_b32 v167, 0
    v_mov_b32 v168, 0
    v_mov_b32 v169, 0
    v_mov_b32 v170, 0
    v_mov_b32 v171, 0
    v_mov_b32 v172, 0
    v_mov_b32 v173, 0
    v_mov_b32 v174, 0
    v_mov_b32 v175, 0
    v_mov_b32 v176, 0
    v_mov_b32 v177, 0
    v_mov_b32 v178, 0
    v_mov_b32 v179, 0
    v_mov_b32 v180, 0
    v_mov_b32 v181, 0
    v_mov_b32 v182, 0
    v_mov_b32 v183, 0
    v_mov_b32 v184, 0
    v_mov_b32 v185, 0
    v_mov_b32 v186, 0
    v_mov_b32 v187, 0
    v_mov_b32 v188, 0
    v_mov_b32 v189, 0
    v_mov_b32 v190, 0
    v_mov_b32 v191, 0
    v_mov_b32 v192, 0
    v_mov_b32 v193, 0
    v_mov_b32 v194, 0
    v_mov_b32 v195, 0
    v_mov_b32 v196, 0
    v_mov_b32 v197, 0
    v_mov_b32 v198, 0
    v_mov_b32 v199, 0
    v_mov_b32 v200, 0
    v_mov_b32 v201, 0
    v_mov_b32 v202, 0
    v_mov_b32 v203, 0
    v_mov_b32 v204, 0
    v_mov_b32 v205, 0
    v_mov_b32 v206, 0
    v_mov_b32 v207, 0
    v_mov_b32 v208, 0
    v_mov_b32 v209, 0
    v_mov_b32 v210, 0
    v_mov_b32 v211, 0
    v_mov_b32 v212, 0
    v_mov_b32 v213, 0
    v_mov_b32 v214, 0
    v_mov_b32 v215, 0
    v_mov_b32 v216, 0
    v_mov_b32 v217, 0
    v_mov_b32 v218, 0
    v_mov_b32 v219, 0
    v_mov_b32 v220, 0
    v_mov_b32 v221, 0
    v_mov_b32 v222, 0
    v_mov_b32 v223, 0
    v_mov_b32 v224, 0
    v_mov_b32 v225, 0
    v_mov_b32 v226, 0
    v_mov_b32 v227, 0
    v_mov_b32 v228, 0
    v_mov_b32 v229, 0
    v_mov_b32 v230, 0
    v_mov_b32 v231, 0
    s_mov_b32 s28, 0
    s_barrier
    v_add_u32 v16, s28, v12
    v_add_u32 v17, s28, v13
    v_add_u32 v18, s28, v14
    v_add_u32 v19, s28, v15
    s_add_u32 s28, s28, 45056
    s_cmp_ge_u32 s28, 135168
    s_cselect_b32 s49, 135168, 0
    s_sub_u32 s28, s28, s49
    ds_read_b128 v[32:35], v16 offset:0
    ds_read_b128 v[36:39], v16 offset:2048
    ds_read_b128 v[40:43], v16 offset:4096
    ds_read_b128 v[44:47], v16 offset:6144
    ds_read_b64_tr_b16 v[64:65], v18 offset:0
    ds_read_b64_tr_b16 v[66:67], v18 offset:1792
    ds_read_b64_tr_b16 v[68:69], v19 offset:0
    ds_read_b64_tr_b16 v[70:71], v19 offset:1792
    ds_read_b64_tr_b16 v[72:73], v18 offset:64
    ds_read_b64_tr_b16 v[74:75], v18 offset:1856
    ds_read_b64_tr_b16 v[76:77], v19 offset:64
    ds_read_b64_tr_b16 v[78:79], v19 offset:1856
    ds_read_b64_tr_b16 v[80:81], v18 offset:128
    ds_read_b64_tr_b16 v[82:83], v18 offset:1920
    ds_read_b64_tr_b16 v[84:85], v19 offset:128
    ds_read_b64_tr_b16 v[86:87], v19 offset:1920
    ds_read_b64_tr_b16 v[88:89], v18 offset:192
    ds_read_b64_tr_b16 v[90:91], v18 offset:1984
    s_sub_u32 s24, s24, 1
g1_loop:
    s_waitcnt lgkmcnt(0)
    v_mfma_f32_16x16x32_bf16 v[120:123], v[64:67], v[32:35], v[120:123]
    ds_read_b128 v[48:51], v17 offset:0
    v_mfma_f32_16x16x32_bf16 v[148:151], v[64:67], v[36:39], v[148:151]
    ds_read_b128 v[52:55], v17 offset:2048
    v_mfma_f32_16x16x32_bf16 v[176:179], v[64:67], v[40:43], v[176:179]
    ds_read_b128 v[56:59], v17 offset:4096
    v_mfma_f32_16x16x32_bf16 v[204:207], v[64:67], v[44:47], v[204:207]
    ds_read_b128 v[60:63], v17 offset:6144
    v_mfma_f32_16x16x32_bf16 v[124:127], v[68:71], v[32:35], v[124:127]
    ds_read_b64_tr_b16 v[92:93], v18 offset:14336
    v_mfma_f32_16x16x32_bf16 v[152:155], v[68:71], v[36:39], v[152:155]
    ds_read_b64_tr_b16 v[94:95], v18 offset:16128
    v_mfma_f32_16x16x32_bf16 v[180:183], v[68:71], v[40:43], v[180:183]
    ds_read_b64_tr_b16 v[96:97], v19 offset:14336
    v_mfma_f32_16x16x32_bf16 v[208:211], v[68:71], v[44:47], v[208:211]
    ds_read_b64_tr_b16 v[98:99], v19 offset:16128
    v_mfma_f32_16x16x32_bf16 v[128:131], v[72:75], v[32:35], v[128:131]
    ds_read_b64_tr_b16 v[100:101], v18 offset:14400
    v_mfma_f32_16x16x32_bf16 v[156:159], v[72:75], v[36:39], v[156:159]
    ds_read_b64_tr_b16 v[102:103], v18 offset:16192
    v_mfma_f32_16x16x32_bf16 v[184:187], v[72:75], v[40:43], v[184:187]
    ds_read_b64_tr_b16 v[104:105], v19 offset:14400
    v_mfma_f32_16x16x32_bf16 v[212:215], v[72:75], v[44:47], v[212:215]
    ds_read_b64_tr_b16 v[106:107], v19 offset:16192
    v_mfma_f32_16x16x32_bf16 v[132:135], v[76:79], v[32:35], v[132:135]
    ds_read_b64_tr_b16 v[108:109], v18 offset:14464
    v_mfma_f32_16x16x32_bf16 v[160:163], v[76:79], v[36:39], v[160:163]
    ds_read_b64_tr_b16 v[110:111], v18 offset:16256
    v_mfma_f32_16x16x32_bf16 v[188:191], v[76:79], v[40:43], v[188:191]
    ds_read_b64_tr_b16 v[112:113], v19 offset:14464
    v_mfma_f32_16x16x32_bf16 v[216:219], v[76:79], v[44:47], v[216:219]
    ds_read_b64_tr_b16 v[114:115], v19 offset:16256
    v_mfma_f32_16x16x32_bf16 v[136:139], v[80:83], v[32:35], v[136:139]
    ds_read_b64_tr_b16 v[116:117], v18 offset:14528
    v_mfma_f32_16x16x32_bf16 v[164:167], v[80:83], v[36:39], v[164:167]
    ds_read_b64_tr_b16 v[118:119], v18 offset:16320
    v_mfma_f32_16x16x32_bf16 v[192:195], v[80:83], v[40:43], v[192:195]
    v_mfma_f32_16x16x32_bf16 v[220:223], v[80:83], v[44:47], v[220:223]
    v_mfma_f32_16x16x32_bf16 v[140:143], v[84:87], v[32:35], v[140:143]
    v_mfma_f32_16x16x32_bf16 v[168:171], v[84:87], v[36:39], v[168:171]
    v_mfma_f32_16x16x32_bf16 v[196:199], v[84:87], v[40:43], v[196:199]
    v_mfma_f32_16x16x32_bf16 v[224:227], v[84:87], v[44:47], v[224:227]
    v_mfma_f32_16x16x32_bf16 v[144:147], v[88:91], v[32:35], v[144:147]
    v_mfma_f32_16x16x32_bf16 v[172:175], v[88:91], v[36:39], v[172:175]
    v_mfma_f32_16x16x32_bf16 v[200:203], v[88:91], v[40:43], v[200:203]
    v_mfma_f32_16x16x32_bf16 v[228:231], v[88:91], v[44:47], v[228:231]
    s_waitcnt lgkmcnt(0)
    s_barrier
    v_add_u32 v16, s28, v12
    v_add_u32 v17, s28, v13
    v_add_u32 v18, s28, v14
    v_add_u32 v19, s28, v15
    v_mfma_f32_16x16x32_bf16 v[120:123], v[92:95], v[48:51], v[120:123]
    ds_read_b128 v[32:35], v16 offset:0
    v_mfma_f32_16x16x32_bf16 v[148:151], v[92:95], v[52:55], v[148:151]
    ds_read_b128 v[36:39], v16 offset:2048
    v_mfma_f32_16x16x32_bf16 v[176:179], v[92:95], v[56:59], v[176:179]
    ds_read_b128 v[40:43], v16 offset:4096
    v_mfma_f32_16x16x32_bf16 v[204:207], v[92:95], v[60:63], v[204:207]
    ds_read_b128 v[44:47], v16 offset:6144
    v_mfma_f32_16x16x32_bf16 v[124:127], v[96:99], v[48:51], v[124:127]
    ds_read_b64_tr_b16 v[64:65], v18 offset:0
    v_mfma_f32_16x16x32_bf16 v[152:155], v[96:99], v[52:55], v[152:155]
    ds_read_b64_tr_b16 v[66:67], v18 offset:1792
    v_mfma_f32_16x16x32_bf16 v[180:183], v[96:99], v[56:59], v[180:183]
    ds_read_b64_tr_b16 v[68:69], v19 offset:0
    v_mfma_f32_16x16x32_bf16 v[208:211], v[96:99], v[60:63], v[208:211]
    ds_read_b64_tr_b16 v[70:71], v19 offset:1792
    v_mfma_f32_16x16x32_bf16 v[128:131], v[100:103], v[48:51], v[128:131]
    ds_read_b64_tr_b16 v[72:73], v18 offset:64
    v_mfma_f32_16x16x32_bf16 v[156:159], v[100:103], v[52:55], v[156:159]
    ds_read_b64_tr_b16 v[74:75], v18 offset:1856
    v_mfma_f32_16x16x32_bf16 v[184:187], v[100:103], v[56:59], v[184:187]
    ds_read_b64_tr_b16 v[76:77], v19 offset:64
    v_mfma_f32_16x16x32_bf16 v[212:215], v[100:103], v[60:63], v[212:215]
    ds_read_b64_tr_b16 v[78:79], v19 offset:1856
    v_mfma_f32_16x16x32_bf16 v[132:135], v[104:107], v[48:51], v[132:135]
    ds_read_b64_tr_b16 v[80:81], v18 offset:128
    v_mfma_f32_16x16x32_bf16 v[160:163], v[104:107], v[52:55], v[160:163]
    ds_read_b64_tr_b16 v[82:83], v18 offset:1920
    v_mfma_f32_16x16x32_bf16 v[188:191], v[104:107], v[56:59], v[188:191]
    ds_read_b64_tr_b16 v[84:85], v19 offset:128
    v_mfma_f32_16x16x32_bf16 v[216:219], v[104:107], v[60:63], v[216:219]
    ds_read_b64_tr_b16 v[86:87], v19 offset:1920
    v_mfma_f32_16x16x32_bf16 v[136:139], v[108:111], v[48:51], v[136:139]
    ds_read_b64_tr_b16 v[88:89], v18 offset:192
    v_mfma_f32_16x16x32_bf16 v[164:167], v[108:111], v[52:55], v[164:167]
    ds_read_b64_tr_b16 v[90:91], v18 offset:1984
    v_mfma_f32_16x16x32_bf16 v[192:195], v[108:111], v[56:59], v[192:195]
    s_add_u32 s28, s28, 45056
    v_mfma_f32_16x16x32_bf16 v[220:223], v[108:111], v[60:63], v[220:223]
    s_cmp_ge_u32 s28, 135168
    v_mfma_f32_16x16x32_bf16 v[140:143], v[112:115], v[48:51], v[140:143]
    s_cselect_b32 s49, 135168, 0
    v_mfma_f32_16x16x32_bf16 v[168:171], v[112:115], v[52:55], v[168:171]
    s_sub_u32 s28, s28, s49
    v_mfma_f32_16x16x32_bf16 v[196:199], v[112:115], v[56:59], v[196:199]
    v_mfma_f32_16x16x32_bf16 v[224:227], v[112:115], v[60:63], v[224:227]
    v_mfma_f32_16x16x32_bf16 v[144:147], v[116:119], v[48:51], v[144:147]
    v_mfma_f32_16x16x32_bf16 v[172:175], v[116:119], v[52:55], v[172:175]
    v_mfma_f32_16x16x32_bf16 v[200:203], v[116:119], v[56:59], v[200:203]
    v_mfma_f32_16x16x32_bf16 v[228:231], v[116:119], v[60:63], v[228:231]
    s_sub_u32 s24, s24, 1
    s_cmp_lg_u32 s24, 0
    s_cbranch_scc1 g1_loop
    s_waitcnt lgkmcnt(0)
    v_mfma_f32_16x16x32_bf16 v[120:123], v[64:67], v[32:35], v[120:123]
    ds_read_b128 v[48:51], v17 offset:0
    v_mfma_f32_16x16x32_bf16 v[148:151], v[64:67], v[36:39], v[148:151]
    ds_read_b128 v[52:55], v17 offset:2048
    v_mfma_f32_16x16x32_bf16 v[176:179], v[64:67], v[40:43], v[176:179]
    ds_read_b128 v[56:59], v17 offset:4096
    v_mfma_f32_16x16x32_bf16 v[204:207], v[64:67], v[44:47], v[204:207]
    ds_read_b128 v[60:63], v17 offset:6144
    v_mfma_f32_16x16x32_bf16 v[124:127], v[68:71], v[32:35], v[124:127]
    ds_read_b64_tr_b16 v[92:93], v18 offset:14336
    v_mfma_f32_16x16x32_bf16 v[152:155], v[68:71], v[36:39], v[152:155]
    ds_read_b64_tr_b16 v[94:95], v18 offset:16128
    v_mfma_f32_16x16x32_bf16 v[180:183], v[68:71], v[40:43], v[180:183]
    ds_read_b64_tr_b16 v[96:97], v19 offset:14336
    v_mfma_f32_16x16x32_bf16 v[208:211], v[68:71], v[44:47], v[208:211]
    ds_read_b64_tr_b16 v[98:99], v19 offset:16128
    v_mfma_f32_16x16x32_bf16 v[128:131], v[72:75], v[32:35], v[128:131]
    ds_read_b64_tr_b16 v[100:101], v18 offset:14400
    v_mfma_f32_16x16x32_bf16 v[156:159], v[72:75], v[36:39], v[156:159]
    ds_read_b64_tr_b16 v[102:103], v18 offset:16192
    v_mfma_f32_16x16x32_bf16 v[184:187], v[72:75], v[40:43], v[184:187]
    ds_read_b64_tr_b16 v[104:105], v19 offset:14400
    v_mfma_f32_16x16x32_bf16 v[212:215], v[72:75], v[44:47], v[212:215]
    ds_read_b64_tr_b16 v[106:107], v19 offset:16192
    v_mfma_f32_16x16x32_bf16 v[132:135], v[76:79], v[32:35], v[132:135]
    ds_read_b64_tr_b16 v[108:109], v18 offset:14464
    v_mfma_f32_16x16x32_bf16 v[160:163], v[76:79], v[36:39], v[160:163]
    ds_read_b64_tr_b16 v[110:111], v18 offset:16256
    v_mfma_f32_16x16x32_bf16 v[188:191], v[76:79], v[40:43], v[188:191]
    ds_read_b64_tr_b16 v[112:113], v19 offset:14464
    v_mfma_f32_16x16x32_bf16 v[216:219], v[76:79], v[44:47], v[216:219]
    ds_read_b64_tr_b16 v[114:115], v19 offset:16256
    v_mfma_f32_16x16x32_bf16 v[136:139], v[80:83], v[32:35], v[136:139]
    ds_read_b64_tr_b16 v[116:117], v18 offset:14528
    v_mfma_f32_16x16x32_bf16 v[164:167], v[80:83], v[36:39], v[164:167]
    ds_read_b64_tr_b16 v[118:119], v18 offset:16320
    v_mfma_f32_16x16x32_bf16 v[192:195], v[80:83], v[40:43], v[192:195]
    v_mfma_f32_16x16x32_bf16 v[220:223], v[80:83], v[44:47], v[220:223]
    v_mfma_f32_16x16x32_bf16 v[140:143], v[84:87], v[32:35], v[140:143]
    v_mfma_f32_16x16x32_bf16 v[168:171], v[84:87], v[36:39], v[168:171]
    v_mfma_f32_16x16x32_bf16 v[196:199], v[84:87], v[40:43], v[196:199]
    v_mfma_f32_16x16x32_bf16 v[224:227], v[84:87], v[44:47], v[224:227]
    v_mfma_f32_16x16x32_bf16 v[144:147], v[88:91], v[32:35], v[144:147]
    v_mfma_f32_16x16x32_bf16 v[172:175], v[88:91], v[36:39], v[172:175]
    v_mfma_f32_16x16x32_bf16 v[200:203], v[88:91], v[40:43], v[200:203]
    v_mfma_f32_16x16x32_bf16 v[228:231], v[88:91], v[44:47], v[228:231]
    s_waitcnt lgkmcnt(0)
    v_mfma_f32_16x16x32_bf16 v[120:123], v[92:95], v[48:51], v[120:123]
    v_mfma_f32_16x16x32_bf16 v[148:151], v[92:95], v[52:55], v[148:151]
    v_mfma_f32_16x16x32_bf16 v[176:179], v[92:95], v[56:59], v[176:179]
    v_mfma_f32_16x16x32_bf16 v[204:207], v[92:95], v[60:63], v[204:207]
    v_mfma_f32_16x16x32_bf16 v[124:127], v[96:99], v[48:51], v[124:127]
    v_mfma_f32_16x16x32_bf16 v[152:155], v[96:99], v[52:55], v[152:155]
    v_mfma_f32_16x16x32_bf16 v[180:183], v[96:99], v[56:59], v[180:183]
    v_mfma_f32_16x16x32_bf16 v[208:211], v[96:99], v[60:63], v[208:211]
    v_mfma_f32_16x16x32_bf16 v[128:131], v[100:103], v[48:51], v[128:131]
    v_mfma_f32_16x16x32_bf16 v[156:159], v[100:103], v[52:55], v[156:159]
    v_mfma_f32_16x16x32_bf16 v[184:187], v[100:103], v[56:59], v[184:187]
    v_mfma_f32_16x16x32_bf16 v[212:215], v[100:103], v[60:63], v[212:215]
    v_mfma_f32_16x16x32_bf16 v[132:135], v[104:107], v[48:51], v[132:135]
    v_mfma_f32_16x16x32_bf16 v[160:163], v[104:107], v[52:55], v[160:163]
    v_mfma_f32_16x16x32_bf16 v[188:191], v[104:107], v[56:59], v[188:191]
    v_mfma_f32_16x16x32_bf16 v[216:219], v[104:107], v[60:63], v[216:219]
    v_mfma_f32_16x16x32_bf16 v[136:139], v[108:111], v[48:51], v[136:139]
    v_mfma_f32_16x16x32_bf16 v[164:167], v[108:111], v[52:55], v[164:167]
    v_mfma_f32_16x16x32_bf16 v[192:195], v[108:111], v[56:59], v[192:195]
    v_mfma_f32_16x16x32_bf16 v[220:223], v[108:111], v[60:63], v[220:223]
    v_mfma_f32_16x16x32_bf16 v[140:143], v[112:115], v[48:51], v[140:143]
    v_mfma_f32_16x16x32_bf16 v[168:171], v[112:115], v[52:55], v[168:171]
    v_mfma_f32_16x16x32_bf16 v[196:199], v[112:115], v[56:59], v[196:199]
    v_mfma_f32_16x16x32_bf16 v[224:227], v[112:115], v[60:63], v[224:227]
    v_mfma_f32_16x16x32_bf16 v[144:147], v[116:119], v[48:51], v[144:147]
    v_mfma_f32_16x16x32_bf16 v[172:175], v[116:119], v[52:55], v[172:175]
    v_mfma_f32_16x16x32_bf16 v[200:203], v[116:119], v[56:59], v[200:203]
    v_mfma_f32_16x16x32_bf16 v[228:231], v[116:119], v[60:63], v[228:231]
    s_nop 7
    s_nop 1
    s_lshl_b32 s45, s33, 4
    s_mov_b32 s46, 0
    v_max_f32 v120, 0, v120
    v_max_f32 v121, 0, v121
    v_max_f32 v122, 0, v122
    v_max_f32 v123, 0, v123
    v_cvt_pk_bf16_f32 v120, v120, v121
    v_cvt_pk_bf16_f32 v121, v122, v123
    v_max_f32 v124, 0, v124
    v_max_f32 v125, 0, v125
    v_max_f32 v126, 0, v126
    v_max_f32 v127, 0, v127
    v_cvt_pk_bf16_f32 v122, v124, v125
    v_cvt_pk_bf16_f32 v123, v126, v127
    v_max_f32 v128, 0, v128
    v_max_f32 v129, 0, v129
    v_max_f32 v130, 0, v130
    v_max_f32 v131, 0, v131
    v_cvt_pk_bf16_f32 v128, v128, v129
    v_cvt_pk_bf16_f32 v129, v130, v131
    v_max_f32 v132, 0, v132
    v_max_f32 v133, 0, v133
    v_max_f32 v134, 0, v134
    v_max_f32 v135, 0, v135
    v_cvt_pk_bf16_f32 v130, v132, v133
    v_cvt_pk_bf16_f32 v131, v134, v135
    v_max_f32 v136, 0, v136
    v_max_f32 v137, 0, v137
    v_max_f32 v138, 0, v138
    v_max_f32 v139, 0, v139
    v_cvt_pk_bf16_f32 v136, v136, v137
    v_cvt_pk_bf16_f32 v137, v138, v139
    v_max_f32 v140, 0, v140
    v_max_f32 v141, 0, v141
    v_max_f32 v142, 0, v142
    v_max_f32 v143, 0, v143
    v_cvt_pk_bf16_f32 v138, v140, v141
    v_cvt_pk_bf16_f32 v139, v142, v143
    v_max_f32 v144, 0, v144
    v_max_f32 v145, 0, v145
    v_max_f32 v146, 0, v146
    v_max_f32 v147, 0, v147
    v_cvt_pk_bf16_f32 v144, v144, v145
    v_cvt_pk_bf16_f32 v145, v146, v147
    s_nop 1
    v_permlane16_swap_b32 v120, v122
    v_permlane16_swap_b32 v121, v123
    v_permlane16_swap_b32 v128, v130
    v_permlane16_swap_b32 v129, v131
    v_permlane16_swap_b32 v136, v138
    v_permlane16_swap_b32 v137, v139
    buffer_store_dwordx4 v[120:123], v30, s[16:19], s46 offen offset:0
    buffer_store_dwordx4 v[128:131], v30, s[16:19], s46 offen offset:64
    buffer_store_dwordx4 v[136:139], v30, s[16:19], s46 offen offset:128
    buffer_store_dwordx2 v[144:145], v28, s[16:19], s46 offen offset:192
    s_add_u32 s46, s46, s45
    v_max_f32 v148, 0, v148
    v_max_f32 v149, 0, v149
    v_max_f32 v150, 0, v150
    v_max_f32 v151, 0, v151
    v_cvt_pk_bf16_f32 v148, v148, v149
    v_cvt_pk_bf16_f32 v149, v150, v151
    v_max_f32 v152, 0, v152
    v_max_f32 v153, 0, v153
    v_max_f32 v154, 0, v154
    v_max_f32 v155, 0, v155
    v_cvt_pk_bf16_f32 v150, v152, v153
    v_cvt_pk_bf16_f32 v151, v154, v155
    v_max_f32 v156, 0, v156
    v_max_f32 v157, 0, v157
    v_max_f32 v158, 0, v158
    v_max_f32 v159, 0, v159
    v_cvt_pk_bf16_f32 v156, v156, v157
    v_cvt_pk_bf16_f32 v157, v158, v159
    v_max_f32 v160, 0, v160
    v_max_f32 v161, 0, v161
    v_max_f32 v162, 0, v162
    v_max_f32 v163, 0, v163
    v_cvt_pk_bf16_f32 v158, v160, v161
    v_cvt_pk_bf16_f32 v159, v162, v163
    v_max_f32 v164, 0, v164
    v_max_f32 v165, 0, v165
    v_max_f32 v166, 0, v166
    v_max_f32 v167, 0, v167
    v_cvt_pk_bf16_f32 v164, v164, v165
    v_cvt_pk_bf16_f32 v165, v166, v167
    v_max_f32 v168, 0, v168
    v_max_f32 v169, 0, v169
    v_max_f32 v170, 0, v170
    v_max_f32 v171, 0, v171
    v_cvt_pk_bf16_f32 v166, v168, v169
    v_cvt_pk_bf16_f32 v167, v170, v171
    v_max_f32 v172, 0, v172
    v_max_f32 v173, 0, v173
    v_max_f32 v174, 0, v174
    v_max_f32 v175, 0, v175
    v_cvt_pk_bf16_f32 v172, v172, v173
    v_cvt_pk_bf16_f32 v173, v174, v175
    s_nop 1
    v_permlane16_swap_b32 v148, v150
    v_permlane16_swap_b32 v149, v151
    v_permlane16_swap_b32 v156, v158
    v_permlane16_swap_b32 v157, v159
    v_permlane16_swap_b32 v164, v166
    v_permlane16_swap_b32 v165, v167
    buffer_store_dwordx4 v[148:151], v30, s[16:19], s46 offen offset:0
    buffer_store_dwordx4 v[156:159], v30, s[16:19], s46 offen offset:64
    buffer_store_dwordx4 v[164:167], v30, s[16:19], s46 offen offset:128
    buffer_store_dwordx2 v[172:173], v28, s[16:19], s46 offen offset:192
    s_add_u32 s46, s46, s45
    v_max_f32 v176, 0, v176
    v_max_f32 v177, 0, v177
    v_max_f32 v178, 0, v178
    v_max_f32 v179, 0, v179
    v_cvt_pk_bf16_f32 v176, v176, v177
    v_cvt_pk_bf16_f32 v177, v178, v179
    v_max_f32 v180, 0, v180
    v_max_f32 v181, 0, v181
    v_max_f32 v182, 0, v182
    v_max_f32 v183, 0, v183
    v_cvt_pk_bf16_f32 v178, v180, v181
    v_cvt_pk_bf16_f32 v179, v182, v183
    v_max_f32 v184, 0, v184
    v_max_f32 v185, 0, v185
    v_max_f32 v186, 0, v186
    v_max_f32 v187, 0, v187
    v_cvt_pk_bf16_f32 v184, v184, v185
    v_cvt_pk_bf16_f32 v185, v186, v187
    v_max_f32 v188, 0, v188
    v_max_f32 v189, 0, v189
    v_max_f32 v190, 0, v190
    v_max_f32 v191, 0, v191
    v_cvt_pk_bf16_f32 v186, v188, v189
    v_cvt_pk_bf16_f32 v187, v190, v191
    v_max_f32 v192, 0, v192
    v_max_f32 v193, 0, v193
    v_max_f32 v194, 0, v194
    v_max_f32 v195, 0, v195
    v_cvt_pk_bf16_f32 v192, v192, v193
    v_cvt_pk_bf16_f32 v193, v194, v195
    v_max_f32 v196, 0, v196
    v_max_f32 v197, 0, v197
    v_max_f32 v198, 0, v198
    v_max_f32 v199, 0, v199
    v_cvt_pk_bf16_f32 v194, v196, v197
    v_cvt_pk_bf16_f32 v195, v198, v199
    v_max_f32 v200, 0, v200
    v_max_f32 v201, 0, v201
    v_max_f32 v202, 0, v202
    v_max_f32 v203, 0, v203
    v_cvt_pk_bf16_f32 v200, v200, v201
    v_cvt_pk_bf16_f32 v201, v202, v203
    s_nop 1
    v_permlane16_swap_b32 v176, v178
    v_permlane16_swap_b32 v177, v179
    v_permlane16_swap_b32 v184, v186
    v_permlane16_swap_b32 v185, v187
    v_permlane16_swap_b32 v192, v194
    v_permlane16_swap_b32 v193, v195
    buffer_store_dwordx4 v[176:179], v30, s[16:19], s46 offen offset:0
    buffer_store_dwordx4 v[184:187], v30, s[16:19], s46 offen offset:64
    buffer_store_dwordx4 v[192:195], v30, s[16:19], s46 offen offset:128
    buffer_store_dwordx2 v[200:201], v28, s[16:19], s46 offen offset:192
    s_add_u32 s46, s46, s45
    v_max_f32 v204, 0, v204
    v_max_f32 v205, 0, v205
    v_max_f32 v206, 0, v206
    v_max_f32 v207, 0, v207
    v_cvt_pk_bf16_f32 v204, v204, v205
    v_cvt_pk_bf16_f32 v205, v206, v207
    v_max_f32 v208, 0, v208
    v_max_f32 v209, 0, v209
    v_max_f32 v210, 0, v210
    v_max_f32 v211, 0, v211
    v_cvt_pk_bf16_f32 v206, v208, v209
    v_cvt_pk_bf16_f32 v207, v210, v211
    v_max_f32 v212, 0, v212
    v_max_f32 v213, 0, v213
    v_max_f32 v214, 0, v214
    v_max_f32 v215, 0, v215
    v_cvt_pk_bf16_f32 v212, v212, v213
    v_cvt_pk_bf16_f32 v213, v214, v215
    v_max_f32 v216, 0, v216
    v_max_f32 v217, 0, v217
    v_max_f32 v218, 0, v218
    v_max_f32 v219, 0, v219
    v_cvt_pk_bf16_f32 v214, v216, v217
    v_cvt_pk_bf16_f32 v215, v218, v219
    v_max_f32 v220, 0, v220
    v_max_f32 v221, 0, v221
    v_max_f32 v222, 0, v222
    v_max_f32 v223, 0, v223
    v_cvt_pk_bf16_f32 v220, v220, v221
    v_cvt_pk_bf16_f32 v221, v222, v223
    v_max_f32 v224, 0, v224
    v_max_f32 v225, 0, v225
    v_max_f32 v226, 0, v226
    v_max_f32 v227, 0, v227
    v_cvt_pk_bf16_f32 v222, v224, v225
    v_cvt_pk_bf16_f32 v223, v226, v227
    v_max_f32 v228, 0, v228
    v_max_f32 v229, 0, v229
    v_max_f32 v230, 0, v230
    v_max_f32 v231, 0, v231
    v_cvt_pk_bf16_f32 v228, v228, v229
    v_cvt_pk_bf16_f32 v229, v230, v231
    s_nop 1
    v_permlane16_swap_b32 v204, v206
    v_permlane16_swap_b32 v205, v207
    v_permlane16_swap_b32 v212, v214
    v_permlane16_swap_b32 v213, v215
    v_permlane16_swap_b32 v220, v222
    v_permlane16_swap_b32 v221, v223
    buffer_store_dwordx4 v[204:207], v30, s[16:19], s46 offen offset:0
    buffer_store_dwordx4 v[212:215], v30, s[16:19], s46 offen offset:64
    buffer_store_dwordx4 v[220:223], v30, s[16:19], s46 offen offset:128
    buffer_store_dwordx2 v[228:229], v28, s[16:19], s46 offen offset:192
    s_add_u32 s46, s46, s45
g1_end:
    s_endpgm
.globl g2_kernel
.p2align 8
.type g2_kernel,@function
g2_kernel:
    s_cmp_ge_u32 s2, 256
    s_cbranch_scc1 g2_end
    s_load_dwordx2 s[40:41], s[0:1], 80
    s_and_b32 s50, s2, 7
    s_lshr_b32 s51, s2, 3
    s_and_b32 s52, s50, 3
    s_lshl_b32 s52, s52, 2
    s_and_b32 s53, s51, 3
    s_add_u32 s54, s52, s53
    s_lshr_b32 s52, s50, 2
    s_lshl_b32 s52, s52, 3
    s_lshr_b32 s53, s51, 2
    s_add_u32 s55, s52, s53
    s_load_dwordx2 s[6:7], s[0:1], 56
    s_load_dwordx2 s[36:37], s[0:1], 64
    s_mov_b32 s31, 7168
    s_mov_b32 s32, 2048
    s_mov_b32 s33, 2048
    s_mov_b32 s24, 56
    s_waitcnt lgkmcnt(0)
    s_mul_i32 s52, s54, 917504
    s_sub_u32 s42, 14680064, s52
    s_add_u32 s52, s52, 25165824
    s_add_u32 s4, s40, s52
    s_addc_u32 s5, s41, 0
    s_mul_i32 s52, s55, 128
    s_sub_u32 s43, 7340032, s52
    s_add_u32 s6, s6, s52
    s_addc_u32 s7, s7, 0
    s_mul_i32 s52, s54, 262144
    s_mul_i32 s53, s55, 128
    s_add_u32 s52, s52, s53
    s_sub_u32 s44, 4194304, s52
    s_add_u32 s36, s36, s52
    s_addc_u32 s37, s37, 0
    s_add_u32 s52, s52, 20971520
    s_add_u32 s38, s40, s52
    s_addc_u32 s39, s41, 0
    s_mov_b32 s8, s4
    s_mov_b32 s9, s5
    s_mov_b32 s10, s42
    s_mov_b32 s11, 0x00020000
    s_mov_b32 s12, s6
    s_mov_b32 s13, s7
    s_mov_b32 s14, s43
    s_mov_b32 s15, 0x00020000
    s_mov_b32 s16, s36
    s_mov_b32 s17, s37
    s_mov_b32 s18, s44
    s_mov_b32 s19, 0x00020000
    s_mov_b32 s20, s38
    s_mov_b32 s21, s39
    s_mov_b32 s22, s44
    s_mov_b32 s23, 0x00020000
    v_lshrrev_b32 v16, 6, v0
    v_and_b32 v0, 63, v0
    v_readfirstlane_b32 s29, v16
    s_nop 3
    s_cmp_lt_u32 s29, 4
    s_cbranch_scc1 g2_compute
    s_sub_u32 s29, s29, 4
    v_subrev_u32 v16, 4, v16
    s_setprio 2
    v_lshrrev_b32 v17, 3, v0
    v_lshl_add_u32 v17, v16, 3, v17
    v_bfe_u32 v18, v17, 1, 3
    v_and_b32 v19, 7, v0
    v_xor_b32 v18, v18, v19
    v_lshlrev_b32 v18, 4, v18
    v_mul_lo_u32 v19, v17, s31
    v_add_u32 v1, v19, v18
    s_lshl_b32 s45, s31, 5
    v_add_u32 v2, s45, v1
    v_add_u32 v3, s45, v2
    v_add_u32 v4, s45, v3
    v_lshl_add_u32 v17, v16, 6, v0
    v_lshrrev_b32 v18, 3, v17
    v_and_b32 v19, 7, v17
    v_and_b32 v20, 2, v18
    v_bfe_u32 v21, v18, 3, 1
    v_lshl_or_b32 v20, v21, 2, v20
    v_xor_b32 v19, v19, v20
    v_mul_lo_u32 v18, v18, s32
    v_lshl_add_u32 v5, v19, 4, v18
    v_lshl_add_u32 v17, v16, 6, v0
    v_add_u32 v17, 256, v17
    v_lshrrev_b32 v18, 3, v17
    v_and_b32 v19, 7, v17
    v_and_b32 v20, 2, v18
    v_bfe_u32 v21, v18, 3, 1
    v_lshl_or_b32 v20, v21, 2, v20
    v_xor_b32 v19, v19, v20
    v_mul_lo_u32 v18, v18, s32
    v_lshl_add_u32 v6, v19, 4, v18
    s_lshl_b32 s34, s32, 6
    s_mov_b32 s25, 0
    s_mov_b32 s26, 0
    s_lshl_b32 s27, s29, 10
    s_add_u32 s48, s27, 147456
    s_mov_b32 m0, s27
    s_nop 0
    buffer_load_dwordx4 v1, s[8:11], s25 offen lds
    s_add_u32 m0, m0, 0x1000
    s_nop 0
    buffer_load_dwordx4 v2, s[8:11], s25 offen lds
    s_add_u32 m0, m0, 0x1000
    s_nop 0
    buffer_load_dwordx4 v3, s[8:11], s25 offen lds
    s_add_u32 m0, m0, 0x1000
    s_nop 0
    buffer_load_dwordx4 v4, s[8:11], s25 offen lds
    s_add_u32 m0, m0, 0x1000
    s_nop 0
    buffer_load_dwordx4 v5, s[12:15], s26 offen lds
    s_add_u32 m0, m0, 0x1000
    s_nop 0
    buffer_load_dwordx4 v6, s[12:15], s26 offen lds
    s_add_u32 s25, s25, 128
    s_add_u32 s26, s26, s34
    s_add_u32 s27, s27, 24576
    s_cmp_ge_u32 s27, s48
    s_cselect_b32 s49, 147456, 0
    s_sub_u32 s27, s27, s49
    s_mov_b32 m0, s27
    s_nop 0
    buffer_load_dwordx4 v1, s[8:11], s25 offen lds
    s_add_u32 m0, m0, 0x1000
    s_nop 0
    buffer_load_dwordx4 v2, s[8:11], s25 offen lds
    s_add_u32 m0, m0, 0x1000
    s_nop 0
    buffer_load_dwordx4 v3, s[8:11], s25 offen lds
    s_add_u32 m0, m0, 0x1000
    s_nop 0
    buffer_load_dwordx4 v4, s[8:11], s25 offen lds
    s_add_u32 m0, m0, 0x1000
    s_nop 0
    buffer_load_dwordx4 v5, s[12:15], s26 offen lds
    s_add_u32 m0, m0, 0x1000
    s_nop 0
    buffer_load_dwordx4 v6, s[12:15], s26 offen lds
    s_add_u32 s25, s25, 128
    s_add_u32 s26, s26, s34
    s_add_u32 s27, s27, 24576
    s_cmp_ge_u32 s27, s48
    s_cselect_b32 s49, 147456, 0
    s_sub_u32 s27, s27, s49
    s_mov_b32 m0, s27
    s_nop 0
    buffer_load_dwordx4 v1, s[8:11], s25 offen lds
    s_add_u32 m0, m0, 0x1000
    s_nop 0
    buffer_load_dwordx4 v2, s[8:11], s25 offen lds
    s_add_u32 m0, m0, 0x1000
    s_nop 0
    buffer_load_dwordx4 v3, s[8:11], s25 offen lds
    s_add_u32 m0, m0, 0x1000
    s_nop 0
    buffer_load_dwordx4 v4, s[8:11], s25 offen lds
    s_add_u32 m0, m0, 0x1000
    s_nop 0
    buffer_load_dwordx4 v5, s[12:15], s26 offen lds
    s_add_u32 m0, m0, 0x1000
    s_nop 0
    buffer_load_dwordx4 v6, s[12:15], s26 offen lds
    s_add_u32 s25, s25, 128
    s_add_u32 s26, s26, s34
    s_add_u32 s27, s27, 24576
    s_cmp_ge_u32 s27, s48
    s_cselect_b32 s49, 147456, 0
    s_sub_u32 s27, s27, s49
    s_mov_b32 m0, s27
    s_nop 0
    buffer_load_dwordx4 v1, s[8:11], s25 offen lds
    s_add_u32 m0, m0, 0x1000
    s_nop 0
    buffer_load_dwordx4 v2, s[8:11], s25 offen lds
    s_add_u32 m0, m0, 0x1000
    s_nop 0
    buffer_load_dwordx4 v3, s[8:11], s25 offen lds
    s_add_u32 m0, m0, 0x1000
    s_nop 0
    buffer_load_dwordx4 v4, s[8:11], s25 offen lds
    s_add_u32 m0, m0, 0x1000
    s_nop 0
    buffer_load_dwordx4 v5, s[12:15], s26 offen lds
    s_add_u32 m0, m0, 0x1000
    s_nop 0
    buffer_load_dwordx4 v6, s[12:15], s26 offen lds
    s_add_u32 s25, s25, 128
    s_add_u32 s26, s26, s34
    s_add_u32 s27, s27, 24576
    s_cmp_ge_u32 s27, s48
    s_cselect_b32 s49, 147456, 0
    s_sub_u32 s27, s27, s49
    s_mov_b32 m0, s27
    s_nop 0
    buffer_load_dwordx4 v1, s[8:11], s25 offen lds
    s_add_u32 m0, m0, 0x1000
    s_nop 0
    buffer_load_dwordx4 v2, s[8:11], s25 offen lds
    s_add_u32 m0, m0, 0x1000
    s_nop 0
    buffer_load_dwordx4 v3, s[8:11], s25 offen lds
    s_add_u32 m0, m0, 0x1000
    s_nop 0
    buffer_load_dwordx4 v4, s[8:11], s25 offen lds
    s_add_u32 m0, m0, 0x1000
    s_nop 0
    buffer_load_dwordx4 v5, s[12:15], s26 offen lds
    s_add_u32 m0, m0, 0x1000
    s_nop 0
    buffer_load_dwordx4 v6, s[12:15], s26 offen lds
    s_add_u32 s25, s25, 128
    s_add_u32 s26, s26, s34
    s_add_u32 s27, s27, 24576
    s_cmp_ge_u32 s27, s48
    s_cselect_b32 s49, 147456, 0
    s_sub_u32 s27, s27, s49
    s_mov_b32 m0, s27
    s_nop 0
    buffer_load_dwordx4 v1, s[8:11], s25 offen lds
    s_add_u32 m0, m0, 0x1000
    s_nop 0
    buffer_load_dwordx4 v2, s[8:11], s25 offen lds
    s_add_u32 m0, m0, 0x1000
    s_nop 0
    buffer_load_dwordx4 v3, s[8:11], s25 offen lds
    s_add_u32 m0, m0, 0x1000
    s_nop 0
    buffer_load_dwordx4 v4, s[8:11], s25 offen lds
    s_add_u32 m0, m0, 0x1000
    s_nop 0
    buffer_load_dwordx4 v5, s[12:15], s26 offen lds
    s_add_u32 m0, m0, 0x1000
    s_nop 0
    buffer_load_dwordx4 v6, s[12:15], s26 offen lds
    s_add_u32 s25, s25, 128
    s_add_u32 s26, s26, s34
    s_add_u32 s27, s27, 24576
    s_cmp_ge_u32 s27, s48
    s_cselect_b32 s49, 147456, 0
    s_sub_u32 s27, s27, s49
    s_waitcnt vmcnt(30)
    s_barrier
    s_sub_u32 s24, s24, 6
    s_cmp_eq_u32 s24, 0
    s_cbranch_scc1 g2_ltail
g2_lloop:
    s_waitcnt vmcnt(24)
    s_barrier
    s_mov_b32 m0, s27
    s_nop 0
    buffer_load_dwordx4 v1, s[8:11], s25 offen lds
    s_add_u32 m0, m0, 0x1000
    s_nop 0
    buffer_load_dwordx4 v2, s[8:11], s25 offen lds
    s_add_u32 m0, m0, 0x1000
    s_nop 0
    buffer_load_dwordx4 v3, s[8:11], s25 offen lds
    s_add_u32 m0, m0, 0x1000
    s_nop 0
    buffer_load_dwordx4 v4, s[8:11], s25 offen lds
    s_add_u32 m0, m0, 0x1000
    s_nop 0
    buffer_load_dwordx4 v5, s[12:15], s26 offen lds
    s_add_u32 m0, m0, 0x1000
    s_nop 0
    buffer_load_dwordx4 v6, s[12:15], s26 offen lds
    s_add_u32 s25, s25, 128
    s_add_u32 s26, s26, s34
    s_add_u32 s27, s27, 24576
    s_cmp_ge_u32 s27, s48
    s_cselect_b32 s49, 147456, 0
    s_sub_u32 s27, s27, s49
    s_sub_u32 s24, s24, 1
    s_cmp_lg_u32 s24, 0
    s_cbranch_scc1 g2_lloop
g2_ltail:
    s_waitcnt vmcnt(24)
    s_barrier
    s_waitcnt vmcnt(18)
    s_barrier
    s_waitcnt vmcnt(12)
    s_barrier
    s_waitcnt vmcnt(6)
    s_barrier
    s_waitcnt vmcnt(0)
    s_barrier
    s_endpgm
g2_compute:
    s_lshl_b32 s84, s32, 6
    s_lshr_b32 s46, s29, 1
    s_and_b32 s47, s29, 1
    v_and_b32 v17, 15, v0
    v_lshrrev_b32 v18, 4, v0
    v_lshrrev_b32 v19, 1, v17
    v_xor_b32 v19, v19, v18
    v_lshlrev_b32 v19, 4, v19
    v_lshl_add_u32 v19, v17, 7, v19
    s_mul_i32 s45, s46, 8192
    v_add_u32 v7, s45, v19
    v_xor_b32 v8, 64, v7
    v_lshrrev_b32 v19, 2, v17
    v_lshl_add_u32 v20, v18, 3, v19
    v_and_b32 v19, 2, v19
    v_and_b32 v21, 1, v18
    v_lshl_or_b32 v19, v21, 2, v19
    v_mul_u32_u24 v20, 8, v20
    v_bfe_u32 v21, v0, 1, 1
    s_mul_i32 s45, s47, 4
    s_add_u32 s45, s45, 0
    v_add_u32 v9, s45, v21
    v_xor_b32 v9, v9, v19
    v_add_u32 v9, v9, v20
    v_lshlrev_b32 v9, 4, v9
    v_and_b32 v22, 1, v0
    v_lshl_add_u32 v9, v22, 3, v9
    v_add_u32 v9, 16384, v9
    s_mul_i32 s45, s47, 4
    s_add_u32 s45, s45, 2
    v_add_u32 v10, s45, v21
    v_xor_b32 v10, v10, v19
    v_add_u32 v10, v10, v20
    v_lshlrev_b32 v10, 4, v10
    v_and_b32 v22, 1, v0
    v_lshl_add_u32 v10, v22, 3, v10
    v_add_u32 v10, 16384, v10
    s_mul_i32 s45, s46, 64
    v_add_u32 v17, s45, v17
    v_mul_lo_u32 v24, v17, s33
    s_mul_i32 s45, s47, 64
    v_lshlrev_b32 v18, 3, v18
    v_add3_u32 v24, v24, v18, s45
    v_sub_u32 v26, v24, v18
    v_bfe_u32 v19, v0, 4, 1
    v_lshl_add_u32 v26, v19, 5, v26
    v_lshrrev_b32 v19, 5, v0
    v_lshl_add_u32 v26, v19, 4, v26
    s_lshl_b32 s45, s33, 4
    s_mov_b32 s46, 0
    buffer_load_dwordx4 v[28:31], v26, s[20:23], s46 offen offset:0
    s_add_u32 s46, s46, s45
    buffer_load_dwordx4 v[32:35], v26, s[20:23], s46 offen offset:0
    s_add_u32 s46, s46, s45
    buffer_load_dwordx4 v[36:39], v26, s[20:23], s46 offen offset:0
    s_add_u32 s46, s46, s45
    buffer_load_dwordx4 v[40:43], v26, s[20:23], s46 offen offset:0
    s_add_u32 s46, s46, s45
    v_mov_b32 v92, 0
    v_mov_b32 v93, 0
    v_mov_b32 v94, 0
    v_mov_b32 v95, 0
    v_mov_b32 v96, 0
    v_mov_b32 v97, 0
    v_mov_b32 v98, 0
    v_mov_b32 v99, 0
    v_mov_b32 v100, 0
    v_mov_b32 v101, 0
    v_mov_b32 v102, 0
    v_mov_b32 v103, 0
    v_mov_b32 v104, 0
    v_mov_b32 v105, 0
    v_mov_b32 v106, 0
    v_mov_b32 v107, 0
    v_mov_b32 v108, 0
    v_mov_b32 v109, 0
    v_mov_b32 v110, 0
    v_mov_b32 v111, 0
    v_mov_b32 v112, 0
    v_mov_b32 v113, 0
    v_mov_b32 v114, 0
    v_mov_b32 v115, 0
    v_mov_b32 v116, 0
    v_mov_b32 v117, 0
    v_mov_b32 v118, 0
    v_mov_b32 v119, 0
    v_mov_b32 v120, 0
    v_mov_b32 v121, 0
    v_mov_b32 v122, 0
    v_mov_b32 v123, 0
    s_mov_b32 s28, 0
    s_barrier
    v_add_u32 v11, s28, v7
    v_add_u32 v12, s28, v8
    v_add_u32 v13, s28, v9
    v_add_u32 v14, s28, v10
    s_add_u32 s28, s28, 24576
    s_cmp_ge_u32 s28, 147456
    s_cselect_b32 s49, 147456, 0
    s_sub_u32 s28, s28, s49
    ds_read_b128 v[44:47], v11 offset:0
    ds_read_b128 v[48:51], v11 offset:2048
    ds_read_b128 v[52:55], v11 offset:4096
    ds_read_b128 v[56:59], v11 offset:6144
    ds_read_b64_tr_b16 v[76:77], v13 offset:0
    ds_read_b64_tr_b16 v[78:79], v13 offset:512
    ds_read_b64_tr_b16 v[80:81], v14 offset:0
    ds_read_b64_tr_b16 v[82:83], v14 offset:512
    s_sub_u32 s24, s24, 1
g2_loop:
    s_waitcnt lgkmcnt(0)
    v_mfma_f32_16x16x32_bf16 v[92:95], v[76:79], v[44:47], v[92:95]
    ds_read_b128 v[60:63], v12 offset:0
    ds_read_b128 v[64:67], v12 offset:2048
    v_mfma_f32_16x16x32_bf16 v[100:103], v[76:79], v[48:51], v[100:103]
    ds_read_b128 v[68:71], v12 offset:4096
    ds_read_b128 v[72:75], v12 offset:6144
    v_mfma_f32_16x16x32_bf16 v[108:111], v[76:79], v[52:55], v[108:111]
    ds_read_b64_tr_b16 v[84:85], v13 offset:4096
    ds_read_b64_tr_b16 v[86:87], v13 offset:4608
    v_mfma_f32_16x16x32_bf16 v[116:119], v[76:79], v[56:59], v[116:119]
    ds_read_b64_tr_b16 v[88:89], v14 offset:4096
    ds_read_b64_tr_b16 v[90:91], v14 offset:4608
    v_mfma_f32_16x16x32_bf16 v[96:99], v[80:83], v[44:47], v[96:99]
    v_mfma_f32_16x16x32_bf16 v[104:107], v[80:83], v[48:51], v[104:107]
    v_mfma_f32_16x16x32_bf16 v[112:115], v[80:83], v[52:55], v[112:115]
    v_mfma_f32_16x16x32_bf16 v[120:123], v[80:83], v[56:59], v[120:123]
    s_waitcnt lgkmcnt(0)
    s_barrier
    v_add_u32 v11, s28, v7
    v_add_u32 v12, s28, v8
    v_add_u32 v13, s28, v9
    v_add_u32 v14, s28, v10
    v_mfma_f32_16x16x32_bf16 v[92:95], v[84:87], v[60:63], v[92:95]
    ds_read_b128 v[44:47], v11 offset:0
    ds_read_b128 v[48:51], v11 offset:2048
    v_mfma_f32_16x16x32_bf16 v[100:103], v[84:87], v[64:67], v[100:103]
    ds_read_b128 v[52:55], v11 offset:4096
    ds_read_b128 v[56:59], v11 offset:6144
    v_mfma_f32_16x16x32_bf16 v[108:111], v[84:87], v[68:71], v[108:111]
    ds_read_b64_tr_b16 v[76:77], v13 offset:0
    ds_read_b64_tr_b16 v[78:79], v13 offset:512
    v_mfma_f32_16x16x32_bf16 v[116:119], v[84:87], v[72:75], v[116:119]
    ds_read_b64_tr_b16 v[80:81], v14 offset:0
    ds_read_b64_tr_b16 v[82:83], v14 offset:512
    v_mfma_f32_16x16x32_bf16 v[96:99], v[88:91], v[60:63], v[96:99]
    s_add_u32 s28, s28, 24576
    s_cmp_ge_u32 s28, 147456
    v_mfma_f32_16x16x32_bf16 v[104:107], v[88:91], v[64:67], v[104:107]
    s_cselect_b32 s49, 147456, 0
    s_sub_u32 s28, s28, s49
    v_mfma_f32_16x16x32_bf16 v[112:115], v[88:91], v[68:71], v[112:115]
    v_mfma_f32_16x16x32_bf16 v[120:123], v[88:91], v[72:75], v[120:123]
    s_sub_u32 s24, s24, 1
    s_cmp_lg_u32 s24, 0
    s_cbranch_scc1 g2_loop
    s_waitcnt lgkmcnt(0)
    v_mfma_f32_16x16x32_bf16 v[92:95], v[76:79], v[44:47], v[92:95]
    ds_read_b128 v[60:63], v12 offset:0
    ds_read_b128 v[64:67], v12 offset:2048
    v_mfma_f32_16x16x32_bf16 v[100:103], v[76:79], v[48:51], v[100:103]
    ds_read_b128 v[68:71], v12 offset:4096
    ds_read_b128 v[72:75], v12 offset:6144
    v_mfma_f32_16x16x32_bf16 v[108:111], v[76:79], v[52:55], v[108:111]
    ds_read_b64_tr_b16 v[84:85], v13 offset:4096
    ds_read_b64_tr_b16 v[86:87], v13 offset:4608
    v_mfma_f32_16x16x32_bf16 v[116:119], v[76:79], v[56:59], v[116:119]
    ds_read_b64_tr_b16 v[88:89], v14 offset:4096
    ds_read_b64_tr_b16 v[90:91], v14 offset:4608
    v_mfma_f32_16x16x32_bf16 v[96:99], v[80:83], v[44:47], v[96:99]
    v_mfma_f32_16x16x32_bf16 v[104:107], v[80:83], v[48:51], v[104:107]
    v_mfma_f32_16x16x32_bf16 v[112:115], v[80:83], v[52:55], v[112:115]
    v_mfma_f32_16x16x32_bf16 v[120:123], v[80:83], v[56:59], v[120:123]
    s_waitcnt lgkmcnt(0)
    v_mfma_f32_16x16x32_bf16 v[92:95], v[84:87], v[60:63], v[92:95]
    v_mfma_f32_16x16x32_bf16 v[100:103], v[84:87], v[64:67], v[100:103]
    v_mfma_f32_16x16x32_bf16 v[108:111], v[84:87], v[68:71], v[108:111]
    v_mfma_f32_16x16x32_bf16 v[116:119], v[84:87], v[72:75], v[116:119]
    v_mfma_f32_16x16x32_bf16 v[96:99], v[88:91], v[60:63], v[96:99]
    v_mfma_f32_16x16x32_bf16 v[104:107], v[88:91], v[64:67], v[104:107]
    v_mfma_f32_16x16x32_bf16 v[112:115], v[88:91], v[68:71], v[112:115]
    v_mfma_f32_16x16x32_bf16 v[120:123], v[88:91], v[72:75], v[120:123]
    s_nop 7
    s_nop 1
    s_lshl_b32 s45, s33, 4
    s_mov_b32 s46, 0
    s_waitcnt vmcnt(0)
    v_permlane16_swap_b32 v28, v30
    v_permlane16_swap_b32 v29, v31
    v_permlane16_swap_b32 v32, v34
    v_permlane16_swap_b32 v33, v35
    v_permlane16_swap_b32 v36, v38
    v_permlane16_swap_b32 v37, v39
    v_permlane16_swap_b32 v40, v42
    v_permlane16_swap_b32 v41, v43
    s_nop 1
    v_lshlrev_b32 v16, 16, v28
    v_and_b32 v17, 0xffff0000, v28
    v_lshlrev_b32 v18, 16, v29
    v_and_b32 v19, 0xffff0000, v29
    v_add_f32 v92, v92, v16
    v_add_f32 v93, v93, v17
    v_add_f32 v94, v94, v18
    v_add_f32 v95, v95, v19
    v_cvt_pk_bf16_f32 v92, v92, v93
    v_cvt_pk_bf16_f32 v93, v94, v95
    v_lshlrev_b32 v16, 16, v30
    v_and_b32 v17, 0xffff0000, v30
    v_lshlrev_b32 v18, 16, v31
    v_and_b32 v19, 0xffff0000, v31
    v_add_f32 v96, v96, v16
    v_add_f32 v97, v97, v17
    v_add_f32 v98, v98, v18
    v_add_f32 v99, v99, v19
    v_cvt_pk_bf16_f32 v94, v96, v97
    v_cvt_pk_bf16_f32 v95, v98, v99
    s_nop 1
    v_permlane16_swap_b32 v92, v94
    v_permlane16_swap_b32 v93, v95
    buffer_store_dwordx4 v[92:95], v26, s[16:19], s46 offen offset:0
    s_add_u32 s46, s46, s45
    v_lshlrev_b32 v16, 16, v32
    v_and_b32 v17, 0xffff0000, v32
    v_lshlrev_b32 v18, 16, v33
    v_and_b32 v19, 0xffff0000, v33
    v_add_f32 v100, v100, v16
    v_add_f32 v101, v101, v17
    v_add_f32 v102, v102, v18
    v_add_f32 v103, v103, v19
    v_cvt_pk_bf16_f32 v100, v100, v101
    v_cvt_pk_bf16_f32 v101, v102, v103
    v_lshlrev_b32 v16, 16, v34
    v_and_b32 v17, 0xffff0000, v34
    v_lshlrev_b32 v18, 16, v35
    v_and_b32 v19, 0xffff0000, v35
    v_add_f32 v104, v104, v16
    v_add_f32 v105, v105, v17
    v_add_f32 v106, v106, v18
    v_add_f32 v107, v107, v19
    v_cvt_pk_bf16_f32 v102, v104, v105
    v_cvt_pk_bf16_f32 v103, v106, v107
    s_nop 1
    v_permlane16_swap_b32 v100, v102
    v_permlane16_swap_b32 v101, v103
    buffer_store_dwordx4 v[100:103], v26, s[16:19], s46 offen offset:0
    s_add_u32 s46, s46, s45
    v_lshlrev_b32 v16, 16, v36
    v_and_b32 v17, 0xffff0000, v36
    v_lshlrev_b32 v18, 16, v37
    v_and_b32 v19, 0xffff0000, v37
    v_add_f32 v108, v108, v16
    v_add_f32 v109, v109, v17
    v_add_f32 v110, v110, v18
    v_add_f32 v111, v111, v19
    v_cvt_pk_bf16_f32 v108, v108, v109
    v_cvt_pk_bf16_f32 v109, v110, v111
    v_lshlrev_b32 v16, 16, v38
    v_and_b32 v17, 0xffff0000, v38
    v_lshlrev_b32 v18, 16, v39
    v_and_b32 v19, 0xffff0000, v39
    v_add_f32 v112, v112, v16
    v_add_f32 v113, v113, v17
    v_add_f32 v114, v114, v18
    v_add_f32 v115, v115, v19
    v_cvt_pk_bf16_f32 v110, v112, v113
    v_cvt_pk_bf16_f32 v111, v114, v115
    s_nop 1
    v_permlane16_swap_b32 v108, v110
    v_permlane16_swap_b32 v109, v111
    buffer_store_dwordx4 v[108:111], v26, s[16:19], s46 offen offset:0
    s_add_u32 s46, s46, s45
    v_lshlrev_b32 v16, 16, v40
    v_and_b32 v17, 0xffff0000, v40
    v_lshlrev_b32 v18, 16, v41
    v_and_b32 v19, 0xffff0000, v41
    v_add_f32 v116, v116, v16
    v_add_f32 v117, v117, v17
    v_add_f32 v118, v118, v18
    v_add_f32 v119, v119, v19
    v_cvt_pk_bf16_f32 v116, v116, v117
    v_cvt_pk_bf16_f32 v117, v118, v119
    v_lshlrev_b32 v16, 16, v42
    v_and_b32 v17, 0xffff0000, v42
    v_lshlrev_b32 v18, 16, v43
    v_and_b32 v19, 0xffff0000, v43
    v_add_f32 v120, v120, v16
    v_add_f32 v121, v121, v17
    v_add_f32 v122, v122, v18
    v_add_f32 v123, v123, v19
    v_cvt_pk_bf16_f32 v118, v120, v121
    v_cvt_pk_bf16_f32 v119, v122, v123
    s_nop 1
    v_permlane16_swap_b32 v116, v118
    v_permlane16_swap_b32 v117, v119
    buffer_store_dwordx4 v[116:119], v26, s[16:19], s46 offen offset:0
    s_add_u32 s46, s46, s45
g2_end:
    s_endpgm
.section .rodata,"a"
.p2align 6
.amdhsa_kernel prep_kernel
  .amdhsa_next_free_vgpr 96
  .amdhsa_next_free_sgpr 96
  .amdhsa_accum_offset 96
  .amdhsa_group_segment_fixed_size 0
  .amdhsa_kernarg_size 88
  .amdhsa_user_sgpr_count 2
  .amdhsa_user_sgpr_kernarg_segment_ptr 1
  .amdhsa_system_sgpr_workgroup_id_x 1
.end_amdhsa_kernel
.p2align 6
.amdhsa_kernel ga_kernel
  .amdhsa_next_free_vgpr 96
  .amdhsa_next_free_sgpr 96
  .amdhsa_accum_offset 96
  .amdhsa_group_segment_fixed_size 0
  .amdhsa_kernarg_size 88
  .amdhsa_user_sgpr_count 2
  .amdhsa_user_sgpr_kernarg_segment_ptr 1
  .amdhsa_system_sgpr_workgroup_id_x 1
.end_amdhsa_kernel
.p2align 6
.amdhsa_kernel gb_kernel
  .amdhsa_next_free_vgpr 96
  .amdhsa_next_free_sgpr 96
  .amdhsa_accum_offset 96
  .amdhsa_group_segment_fixed_size 0
  .amdhsa_kernarg_size 88
  .amdhsa_user_sgpr_count 2
  .amdhsa_user_sgpr_kernarg_segment_ptr 1
  .amdhsa_system_sgpr_workgroup_id_x 1
.end_amdhsa_kernel
.p2align 6
.amdhsa_kernel ln2_kernel
  .amdhsa_next_free_vgpr 96
  .amdhsa_next_free_sgpr 96
  .amdhsa_accum_offset 96
  .amdhsa_group_segment_fixed_size 0
  .amdhsa_kernarg_size 88
  .amdhsa_user_sgpr_count 2
  .amdhsa_user_sgpr_kernarg_segment_ptr 1
  .amdhsa_system_sgpr_workgroup_id_x 1
.end_amdhsa_kernel
.p2align 6
.amdhsa_kernel g1_kernel
  .amdhsa_next_free_vgpr 232
  .amdhsa_next_free_sgpr 96
  .amdhsa_accum_offset 232
  .amdhsa_group_segment_fixed_size 0
  .amdhsa_kernarg_size 88
  .amdhsa_user_sgpr_count 2
  .amdhsa_user_sgpr_kernarg_segment_ptr 1
  .amdhsa_system_sgpr_workgroup_id_x 1
.end_amdhsa_kernel
.p2align 6
.amdhsa_kernel g2_kernel
  .amdhsa_next_free_vgpr 128
  .amdhsa_next_free_sgpr 96
  .amdhsa_accum_offset 128
  .amdhsa_group_segment_fixed_size 0
  .amdhsa_kernarg_size 88
  .amdhsa_user_sgpr_count 2
  .amdhsa_user_sgpr_kernarg_segment_ptr 1
  .amdhsa_system_sgpr_workgroup_id_x 1
.end_amdhsa_kernel
```
